```python
import torch

def _softmax(x, axis=-1):
    return torch.softmax(x, dim=axis)
def _gelu(x):
    return torch.nn.functional.gelu(x, approximate="tanh")
def _silu(x):
    return torch.nn.functional.silu(x)
def _sigmoid(x):
    return torch.sigmoid(x)
def _layernorm(x, axis=-1, eps=1e-5):
    m = x.mean(dim=axis, keepdim=True)
    v = x.var(dim=axis, keepdim=True, unbiased=False)
    return (x - m) / torch.sqrt(v + eps)
def _scatter_add(tgt, idx, src, axis=0):
    return tgt.clone().index_add_(axis, idx, src)
def _segment_sum(src, seg, n):
    out = torch.zeros((n,) + src.shape[1:], dtype=src.dtype)
    return out.index_add_(0, seg, src)
def _pad(x, pw):
    flat = tuple(v for pair in reversed(pw) for v in pair)
    return torch.nn.functional.pad(x, flat)

kernel_name = 'recurrent_scan__ssm_conv_h3__mixer_token_mlp__prompt'

def setup_inputs():

    _w = (lambda a: (lambda t: t.to(torch.bfloat16) if t.is_floating_point() else t)(torch.as_tensor(a)))
    def _A_setup():
        B, S, D = 1, 2048, 448
        ks = 4
        return {
            "q": _w((lambda *s: torch.randn(*s, dtype=torch.bfloat16) * 0.05)(B, S, D)),
            "k": _w((lambda *s: torch.randn(*s, dtype=torch.bfloat16) * 0.8)(B, S, D)),
            "v": _w((lambda *s: torch.randn(*s, dtype=torch.bfloat16) * 0.8)(B, S, D)),
            "shift_k": _w((lambda *s: torch.randn(*s, dtype=torch.bfloat16) * 0.8)(D, ks) * 0.5),
            "ssm_k": _w((lambda *s: torch.randn(*s, dtype=torch.bfloat16) * 0.8)(D, S) * (1.0 / S ** 0.5)),
            "ssm_D": _w((lambda *s: torch.randn(*s, dtype=torch.bfloat16) * 0.8)(D)),
        }
    _A_in = _A_setup()

    def _B_setup():
        B, S, D, F = 1, 2048, 448, 1792
        return {
            "x": _w((lambda *s: torch.randn(*s, dtype=torch.bfloat16) * 0.05)(B, S, D)),
            "w1": _w((lambda *s: torch.randn(*s, dtype=torch.bfloat16) * 0.8)(S, F) * (S ** -0.5)),
            "b1": _w((lambda *s: torch.randn(*s, dtype=torch.bfloat16) * 12.8)(F) * 0.02),
            "w2": _w((lambda *s: torch.randn(*s, dtype=torch.bfloat16) * 0.2)(F, S) * (F ** -0.5)),
            "b2": _w((lambda *s: torch.randn(*s, dtype=torch.bfloat16) * 1.6)(S) * 0.02),
        }
    _B_in = _B_setup()

    return {
        "A_q": _A_in["q"],
        "A_k": _A_in["k"],
        "A_v": _A_in["v"],
        "A_shift_k": _A_in["shift_k"],
        "A_ssm_k": _A_in["ssm_k"],
        "A_ssm_D": _A_in["ssm_D"],
        "B_x": _B_in["x"],
        "B_w1": _B_in["w1"],
        "B_b1": _B_in["b1"],
        "B_w2": _B_in["w2"],
        "B_b2": _B_in["b2"],
    }

def reference(A_q, A_k, A_v, A_shift_k, A_ssm_k, A_ssm_D, B_x, B_w1, B_b1, B_w2, B_b2):
    def _A_ref(q, k, v, shift_k, ssm_k, ssm_D):
        B, S, D = q.shape
        ks = shift_k.shape[-1]
        k_pad = _pad(k, ((0, 0), (ks - 1, 0), (0, 0)))
        k_shift = torch.zeros_like(k)
        for t in range(ks):
            k_shift = k_shift + k_pad[:, t:t + S, :] * shift_k[:, ks - 1 - t][None, None, :]
        kv = k_shift * v
        L = 2 * S
        kv_pad = _pad(kv, ((0, 0), (0, S), (0, 0)))
        kf_pad = _pad(ssm_k, ((0, 0), (0, S)))
        kv_f = (lambda x, axes=(-2,-1): torch.fft.rfft2(x.float(), dim=axes))(kv_pad[:, None, :, :], axes=(1, 2))
        kf_f = (lambda x, axes=(-2,-1): torch.fft.rfft2(x.float(), dim=axes))(kf_pad[:, None, :], axes=(1, 2))
        kf_f = (lambda x, *d: x.permute(*d))(kf_f, 1, 2, 0)
        y_f = kv_f * kf_f[None, :, :, :]
        y = (lambda x, s, axes=(-2,-1): torch.fft.irfft2(x, s=s, dim=axes).to(torch.bfloat16))(y_f, (1, L), axes=(1, 2))[:, 0, :S, :]
        y = y + kv * ssm_D[None, None, :]
        return q * y

    def _B_ref(x, w1, b1, w2, b2):
        B, S, D = x.shape
        h = _layernorm(x, axis=-1)
        u = torch.einsum("bsd,sf->bdf", h, w1) + b1
        u = _gelu(u)
        y = torch.einsum("bdf,fs->bds", u, w2) + b2
        return (lambda x, *d: x.permute(*d))(y, 0, 2, 1)

    x = A_q
    xn = _layernorm(x, axis=-1)
    s = _A_ref(xn, A_k, A_v, A_shift_k, A_ssm_k, A_ssm_D)
    g = _silu(_B_ref(xn, B_w1, B_b1, B_w2, B_b2))
    return x + s * g
```

```asm
; @launch grid=(256,1,1) block=(256,1,1) lds=157184
.amdgcn_target "amdgcn-amd-amdhsa--gfx950"
.text
.globl recurrent_scan__ssm_conv_h3__mixer_token_mlp__prompt_kernel
.p2align 8
.type recurrent_scan__ssm_conv_h3__mixer_token_mlp__prompt_kernel,@function
recurrent_scan__ssm_conv_h3__mixer_token_mlp__prompt_kernel:
  s_cmp_ge_u32 s2, 256
  s_cbranch_scc1 L_END
  s_load_dwordx16 s[4:19], s[0:1], 0
  s_load_dwordx2 s[28:29], s[0:1], 104
  s_load_dwordx8 s[20:27], s[0:1], 64
  v_lshrrev_b32 v2, 6, v0
  v_and_b32 v1, 63, v0
  v_readfirstlane_b32 s56, v2
  s_getpc_b64 s[30:31]
  s_lshr_b32 s62, s2, 3
  s_lshl_b32 s62, s62, 10
  s_lshl_b32 s63, s56, 8
  s_add_u32 s62, s62, s63
  v_lshlrev_b32 v3, 7, v1
  v_add_u32 v3, s62, v3
  v_min_u32 v3, L_END-recurrent_scan__ssm_conv_h3__mixer_token_mlp__prompt_kernel-256, v3
  s_mov_b64 exec, 3
  global_load_dword v253, v3, s[30:31]
  s_mov_b64 exec, -1
  v_lshrrev_b32 v5, 5, v1
  v_and_b32 v6, 31, v1
  v_mov_b32 v69, 0x80000000
  v_lshrrev_b32 v64, 5, v0
  s_lshl_b32 s63, s2, 3
  v_add_u32 v65, s63, v64
  v_mul_u32_u24 v66, 896, v65
  v_lshl_add_u32 v66, v6, 4, v66
  v_cmp_gt_u32 s[76:77], 28, v6
  s_and_b32 s57, s2, 7
  s_lshr_b32 s58, s2, 3
  v_cndmask_b32 v66, v69, v66, s[76:77]
  s_waitcnt lgkmcnt(0)
  s_mov_b32 s36, s4
  s_mov_b32 s37, s5
  s_mov_b32 s38, 0x1c0000
  s_mov_b32 s39, 0x20000
  buffer_load_dwordx4 v[72:75], v66, s[36:39], 0 offen
  buffer_load_dwordx4 v[76:79], v66, s[36:39], 0 offen offset:448
  s_mov_b32 s59, 0xffff0000
  v_mov_b32 v7, 0xa60000
  s_mov_b32 s32, s28
  s_mov_b32 s33, s29
  s_mov_b32 s34, 0x1100000
  s_mov_b32 s35, 0x20000
  buffer_load_dword v255, v7, s[32:35], 0 offen sc1
  s_and_b32 s62, s57, 1
  s_sub_u32 s83, 25, s62
  s_mul_i32 s82, s57, 49
  s_add_u32 s82, s82, 1
  s_lshr_b32 s82, s82, 1
  s_add_u32 s82, s82, s58
  s_mul_i32 s84, s82, 9363
  s_lshr_b32 s84, s84, 16
  s_mul_i32 s85, s84, 7
  s_sub_u32 s85, s82, s85
  v_lshrrev_b32 v2, 3, v1
  v_and_b32 v3, 7, v1
  v_lshrrev_b32 v4, 2, v1
  v_and_b32 v4, 4, v4
  v_xor_b32 v3, v3, v4
  v_mul_u32_u24 v10, 3584, v2
  v_lshl_add_u32 v10, v3, 4, v10
  v_add_u32 v11, 27648, v10
  s_mul_i32 s61, s56, 12288
  s_add_u32 s61, s61, 65536
  s_lshr_b32 s89, s56, 1
  s_lshl_b32 s90, s2, 1
  s_add_u32 s90, s90, s89
  s_lshl_b32 s69, s90, 12
  s_min_u32 s91, s69, 1835008
  s_and_b32 s89, s56, 1
  s_lshl_b32 s89, s89, 11
  v_lshlrev_b32 v200, 4, v1
  v_add_u32 v200, s89, v200
  v_add_u32 v201, 1016, v200
  v_subrev_u32 v202, 8, v200
  v_mov_b32 v203, 0x80000000
  v_cmp_eq_u32 vcc, 0, v200
  s_lshl_b32 s90, s90, 1
  v_mov_b32 v204, s90
  v_cndmask_b32 v202, v202, v203, vcc
  s_mov_b32 s52, s18
  s_mov_b32 s53, s19
  s_mov_b32 s54, 0x700000
  s_mov_b32 s55, 0x20000
  s_mov_b32 s48, s20
  s_mov_b32 s49, s21
  s_mov_b32 s50, 0xe00
  s_mov_b32 s51, 0x20000
  s_lshl_b32 s74, s84, 7
  s_lshr_b32 s90, s56, 1
  s_lshl_b32 s90, s90, 6
  s_add_u32 s74, s74, s90
  s_min_u32 s74, s74, 3584
  s_sub_u32 s75, 31, s58
  s_lshl_b32 s75, s75, 2
  s_add_u32 s75, s75, s56
  s_mov_b64 exec, 1
  v_mov_b32 v218, 0
  buffer_load_dword v219, v218, s[48:51], s74 offen
  s_mov_b32 s48, s14
  s_mov_b32 s49, s15
  s_mov_b32 s50, 0x380
  s_mov_b32 s51, 0x20000
  buffer_load_ushort v205, v204, s[48:51], 0 offen
  s_mov_b64 exec, -1
  s_and_b32 s89, s75, 3
  s_lshl_b32 s89, s89, 5
  s_lshr_b32 s90, s75, 2
  s_add_u32 s89, s89, s90
  s_mul_i32 s73, s89, 57344
  s_mul_i32 s90, s57, 7
  s_lshr_b32 s90, s90, 1
  s_lshl_b32 s90, s90, 7
  s_add_u32 s73, s73, s90
  v_lshrrev_b32 v28, 2, v1
  v_mul_u32_u24 v28, 3584, v28
  v_and_b32 v218, 3, v1
  v_lshl_add_u32 v28, v218, 7, v28
  s_cmp_lt_u32 s75, 28
  s_cbranch_scc1 L_NH1
  s_lshr_b32 s89, s58, 0
  s_add_u32 s89, s89, 7
  s_lshl_b32 s73, s56, 5
  s_add_u32 s89, s89, s73
  s_lshl_b32 s89, s89, 0
  s_and_b32 s73, s58, 0
  s_add_u32 s89, s89, s73
  s_mul_i32 s73, s89, 57344
  s_add_u32 s73, s73, s90
  s_cmp_lt_u32 s58, 25
  s_cselect_b32 s73, s73, s54
  s_mov_b64 exec, 0xffffffff
  s_mov_b32 exec_hi, -1
L_NH1:
  buffer_load_dword v218, v28, s[52:55], s73 offen
  s_add_u32 s73, s73, 401408
  s_mov_b64 exec, -1
  s_mul_i32 s86, s58, 9363
  s_lshr_b32 s86, s86, 16
  s_mul_i32 s87, s86, 7
  s_sub_u32 s87, s58, s87
  s_lshl_b32 s89, s57, 2
  s_add_u32 s86, s86, s89
  v_lshlrev_b32 v8, 12, v2
  v_lshl_add_u32 v8, v3, 4, v8
  v_add_u32 v9, 31744, v8
  v_mul_u32_u24 v12, 7168, v5
  v_lshl_add_u32 v12, v6, 4, v12
  s_and_b32 s62, s56, 1
  s_lshl_b32 s62, s62, 9
  v_add_u32 v16, s62, v12
  s_xor_b32 s62, s62, 512
  v_add_u32 v17, s62, v12
  v_bfe_u32 v7, v1, 2, 2
  v_lshl_add_u32 v4, v5, 3, v7
  v_lshlrev_b32 v21, 7, v4
  v_bfe_u32 v4, v1, 4, 1
  v_and_b32 v7, 2, v7
  v_xor_b32 v4, v4, v7
  v_lshl_add_u32 v21, v4, 5, v21
  v_and_b32 v7, 3, v1
  v_lshl_add_u32 v21, v7, 3, v21
  s_lshr_b32 s62, s56, 1
  s_lshl_b32 s62, s62, 6
  v_xor_b32 v21, s62, v21
  v_add_u32 v13, s61, v21
  v_xor_b32 v14, 64, v13
  v_lshlrev_b32 v4, 4, v1
  s_lshl_b32 s62, s56, 14
  v_add_u32 v15, s62, v4
  s_xor_b32 s63, s62, 16384
  s_add_u32 s63, s63, 4096
  v_add_u32 v18, s63, v4
  s_xor_b32 s63, s62, 32768
  s_add_u32 s63, s63, 8192
  v_add_u32 v19, s63, v4
  s_xor_b32 s63, s62, 49152
  s_add_u32 s63, s63, 12288
  v_add_u32 v20, s63, v4
  s_mul_i32 s80, s56, 1835008
  s_lshl_b32 s62, s86, 7
  s_add_u32 s80, s80, s62
  s_add_u32 s81, s80, 1835008
  s_mul_i32 s95, s87, 0
  s_lshl_b32 s67, s95, 16
  s_add_u32 s67, s67, s80
  s_lshl_b32 s89, s86, 6
  s_lshr_b32 s90, s56, 1
  s_lshl_b32 s90, s90, 5
  s_add_u32 s89, s89, s90
  v_add_u32 v49, s89, v6
  v_mul_u32_u24 v195, 896, v49
  v_lshl_add_u32 v195, v5, 4, v195
  s_lshl_b32 s88, s87, 7
  s_and_b32 s90, s56, 1
  s_lshl_b32 s90, s90, 6
  s_add_u32 s88, s88, s90
  v_lshlrev_b32 v22, 1, v49
  v_lshlrev_b32 v49, 3, v49
  v_add_u32 v49, 0x400000, v49
  s_lshl_b32 s62, s56, 13
  s_add_u32 s62, s62, 0xa00000
  v_lshlrev_b32 v23, 7, v1
  v_add_u32 v23, s62, v23
  s_lshr_b32 s62, s2, 5
  s_lshl_b32 s62, s62, 7
  s_add_u32 s62, s62, 0xa08000
  v_and_b32 v24, 7, v1
  v_mul_u32_u24 v24, 896, v24
  v_add_u32 v24, s62, v24
  s_mov_b32 s48, s22
  s_mov_b32 s49, s23
  s_mov_b32 s50, 0x700000
  s_mov_b32 s51, 0x20000
  v_cndmask_b32 v68, 0, 1.0, s[76:77]
  v_mul_u32_u24 v69, 960, v64
  v_lshl_add_u32 v69, v6, 4, v69
  v_lshlrev_b32 v70, 3, v64
  v_cmp_eq_u32 s[78:79], 0, v6
  v_bfe_u32 v64, v1, 2, 2
  v_mul_u32_u24 v64, 960, v64
  v_lshrrev_b32 v65, 4, v0
  v_lshl_add_u32 v64, v65, 5, v64
  v_and_b32 v65, 3, v1
  v_lshl_add_u32 v64, v65, 3, v64
  v_lshlrev_b32 v66, 4, v0
  s_mul_i32 s93, s2, 7168
  s_add_u32 s94, s93, 4096
  s_lshl_b32 s97, s2, 6
  s_add_u32 s97, s97, 0x400000
  s_lshl_b32 s96, s2, 7
  s_add_u32 s96, s96, 0xa00000
  v_lshlrev_b32 v67, 4, v1
  s_waitcnt vmcnt(4)
  v_lshlrev_b32 v96, 16, v72
  v_and_b32 v97, s59, v72
  v_lshlrev_b32 v98, 16, v73
  v_and_b32 v99, s59, v73
  v_lshlrev_b32 v100, 16, v74
  v_and_b32 v101, s59, v74
  v_lshlrev_b32 v102, 16, v75
  v_and_b32 v103, s59, v75
  v_lshlrev_b32 v104, 16, v76
  v_and_b32 v105, s59, v76
  v_lshlrev_b32 v106, 16, v77
  v_and_b32 v107, s59, v77
  v_lshlrev_b32 v108, 16, v78
  v_and_b32 v109, s59, v78
  v_lshlrev_b32 v110, 16, v79
  v_and_b32 v111, s59, v79
  v_pk_add_f32 v[112:113], v[96:97], v[98:99]
  v_pk_add_f32 v[114:115], v[100:101], v[102:103]
  v_pk_add_f32 v[116:117], v[104:105], v[106:107]
  v_pk_add_f32 v[118:119], v[108:109], v[110:111]
  v_pk_add_f32 v[112:113], v[112:113], v[114:115]
  v_pk_add_f32 v[116:117], v[116:117], v[118:119]
  v_pk_add_f32 v[112:113], v[112:113], v[116:117]
  v_add_f32 v112, v112, v113
  s_nop 1
  v_add_f32_dpp v112, v112, v112 quad_perm:[1,0,3,2] row_mask:0xf bank_mask:0xf
  s_nop 1
  v_add_f32_dpp v112, v112, v112 quad_perm:[2,3,0,1] row_mask:0xf bank_mask:0xf
  s_nop 1
  v_add_f32_dpp v112, v112, v112 row_half_mirror row_mask:0xf bank_mask:0xf
  s_nop 1
  v_add_f32_dpp v112, v112, v112 row_mirror row_mask:0xf bank_mask:0xf
  v_mov_b32 v113, v112
  s_nop 1
  v_permlane16_swap_b32 v113, v112
  s_nop 0
  v_add_f32 v112, v112, v113
  v_mul_f32 v112, 0x3b124925, v112
  v_pk_add_f32 v[96:97], v[96:97], v[112:113] op_sel_hi:[1,0] neg_lo:[0,1] neg_hi:[0,1]
  v_pk_add_f32 v[98:99], v[98:99], v[112:113] op_sel_hi:[1,0] neg_lo:[0,1] neg_hi:[0,1]
  v_pk_add_f32 v[100:101], v[100:101], v[112:113] op_sel_hi:[1,0] neg_lo:[0,1] neg_hi:[0,1]
  v_pk_add_f32 v[102:103], v[102:103], v[112:113] op_sel_hi:[1,0] neg_lo:[0,1] neg_hi:[0,1]
  v_pk_add_f32 v[104:105], v[104:105], v[112:113] op_sel_hi:[1,0] neg_lo:[0,1] neg_hi:[0,1]
  v_pk_add_f32 v[106:107], v[106:107], v[112:113] op_sel_hi:[1,0] neg_lo:[0,1] neg_hi:[0,1]
  v_pk_add_f32 v[108:109], v[108:109], v[112:113] op_sel_hi:[1,0] neg_lo:[0,1] neg_hi:[0,1]
  v_pk_add_f32 v[110:111], v[110:111], v[112:113] op_sel_hi:[1,0] neg_lo:[0,1] neg_hi:[0,1]
  v_pk_mul_f32 v[114:115], v[96:97], v[96:97]
  v_pk_mul_f32 v[116:117], v[98:99], v[98:99]
  v_pk_fma_f32 v[114:115], v[100:101], v[100:101], v[114:115]
  v_pk_fma_f32 v[116:117], v[102:103], v[102:103], v[116:117]
  v_pk_fma_f32 v[114:115], v[104:105], v[104:105], v[114:115]
  v_pk_fma_f32 v[116:117], v[106:107], v[106:107], v[116:117]
  v_pk_fma_f32 v[114:115], v[108:109], v[108:109], v[114:115]
  v_pk_fma_f32 v[116:117], v[110:111], v[110:111], v[116:117]
  v_pk_add_f32 v[114:115], v[114:115], v[116:117]
  v_add_f32 v114, v114, v115
  v_mul_f32 v114, v114, v68
  s_nop 1
  v_add_f32_dpp v114, v114, v114 quad_perm:[1,0,3,2] row_mask:0xf bank_mask:0xf
  s_nop 1
  v_add_f32_dpp v114, v114, v114 quad_perm:[2,3,0,1] row_mask:0xf bank_mask:0xf
  s_nop 1
  v_add_f32_dpp v114, v114, v114 row_half_mirror row_mask:0xf bank_mask:0xf
  s_nop 1
  v_add_f32_dpp v114, v114, v114 row_mirror row_mask:0xf bank_mask:0xf
  v_mov_b32 v115, v114
  s_nop 1
  v_permlane16_swap_b32 v115, v114
  s_nop 0
  v_add_f32 v114, v114, v115
  v_mul_f32 v114, 0x3b124925, v114
  v_add_f32 v115, 0x3727c5ac, v114
  v_rsq_f32 v113, v115
  s_nop 0
  v_mul_f32 v116, v113, v113
  v_fmaak_f32 v116, v116, v114, 0x3727c5ac
  v_rsq_f32 v116, v116
  s_nop 0
  v_mul_f32 v116, v116, v113
  v_pk_mul_f32 v[96:97], v[96:97], v[116:117] op_sel_hi:[1,0]
  v_pk_mul_f32 v[98:99], v[98:99], v[116:117] op_sel_hi:[1,0]
  v_pk_mul_f32 v[100:101], v[100:101], v[116:117] op_sel_hi:[1,0]
  v_pk_mul_f32 v[102:103], v[102:103], v[116:117] op_sel_hi:[1,0]
  v_pk_mul_f32 v[104:105], v[104:105], v[116:117] op_sel_hi:[1,0]
  v_pk_mul_f32 v[106:107], v[106:107], v[116:117] op_sel_hi:[1,0]
  v_pk_mul_f32 v[108:109], v[108:109], v[116:117] op_sel_hi:[1,0]
  v_pk_mul_f32 v[110:111], v[110:111], v[116:117] op_sel_hi:[1,0]
  v_cvt_pk_bf16_f32 v120, v96, v97
  v_cvt_pk_bf16_f32 v121, v98, v99
  v_cvt_pk_bf16_f32 v122, v100, v101
  v_cvt_pk_bf16_f32 v123, v102, v103
  v_cvt_pk_bf16_f32 v124, v104, v105
  v_cvt_pk_bf16_f32 v125, v106, v107
  v_cvt_pk_bf16_f32 v126, v108, v109
  v_cvt_pk_bf16_f32 v127, v110, v111
  s_mov_b64 exec, s[76:77]
  ds_write_b128 v69, v[120:123] offset:0
  ds_write_b128 v69, v[124:127] offset:448
  s_mov_b64 exec, s[78:79]
  ds_write_b64 v70, v[112:113] offset:7680
  s_mov_b64 exec, -1
  s_waitcnt lgkmcnt(0)
  s_barrier
  ds_read_b64_tr_b16 v[72:73], v64 offset:0
  ds_read_b64_tr_b16 v[74:75], v64 offset:3840
  s_cmp_eq_u32 s56, 3
  s_cbranch_scc1 L_A2
  ds_read_b64_tr_b16 v[76:77], v64 offset:512
  ds_read_b64_tr_b16 v[78:79], v64 offset:4352
  s_waitcnt lgkmcnt(0)
  buffer_store_dwordx4 v[76:79], v66, s[32:35], s94 offen sc1
  s_branch L_A3
L_A2:
  ds_read_b128 v[76:79], v67 offset:7680
  s_waitcnt lgkmcnt(0)
  s_mov_b64 exec, 15
  buffer_store_dwordx4 v[76:79], v67, s[32:35], s97 offen sc1
  s_mov_b64 exec, -1
L_A3:
  buffer_store_dwordx4 v[72:75], v66, s[32:35], s93 offen sc1
  s_cmp_lt_u32 s58, s83
  s_cbranch_scc0 L_NOG1
  s_mul_i32 s66, s56, 1835008
  s_lshl_b32 s62, s84, 7
  s_add_u32 s66, s66, s62
  s_call_b64 s[30:31], L_GELU
  s_mov_b32 s44, s20
  s_mov_b32 s45, s21
  s_mov_b32 s46, 0xe00
  s_mov_b32 s47, 0x20000
  v_lshlrev_b32 v203, 4, v5
  buffer_load_dwordx4 v[32:35], v203, s[44:47], s74 offen offset:0
  buffer_load_dwordx4 v[36:39], v203, s[44:47], s74 offen offset:32
  s_add_u32 m0, s61, 0
  s_nop 0
  buffer_load_dwordx4 v10, s[52:55], s66 offen lds
  buffer_load_dwordx4 v11, s[52:55], s66 offen offset:1024 lds
  s_add_u32 m0, s61, 2048
  s_add_u32 s66, s66, 57344
  buffer_load_dwordx4 v10, s[52:55], s66 offen lds
  buffer_load_dwordx4 v11, s[52:55], s66 offen offset:1024 lds
  s_add_u32 m0, s61, 4096
  s_add_u32 s66, s66, 57344
  buffer_load_dwordx4 v10, s[52:55], s66 offen lds
  buffer_load_dwordx4 v11, s[52:55], s66 offen offset:1024 lds
  s_add_u32 m0, s61, 6144
  s_add_u32 s66, s66, 57344
  buffer_load_dwordx4 v10, s[52:55], s66 offen lds
  buffer_load_dwordx4 v11, s[52:55], s66 offen offset:1024 lds
  s_waitcnt vmcnt(10)
  v_add_u32 v255, 1, v255
  s_barrier
  s_cmp_lg_u32 s56, 0
  s_cbranch_scc1 L_FA2
  v_mov_b32 v249, s96
  s_mov_b64 exec, 1
  buffer_store_dword v255, v249, s[32:35], 0 offen sc1
  s_mov_b64 exec, -1
L_FA2:
  v_readfirstlane_b32 s89, v205
  s_nop 1
  v_mov_b32 v205, s89
  s_add_u32 m0, s61, 8192
  s_add_u32 s66, s66, 57344
  buffer_load_dwordx4 v10, s[52:55], s66 offen lds
  buffer_load_dwordx4 v11, s[52:55], s66 offen offset:1024 lds
  s_add_u32 m0, s61, 10240
  s_add_u32 s66, s66, 57344
  buffer_load_dwordx4 v10, s[52:55], s66 offen lds
  buffer_load_dwordx4 v11, s[52:55], s66 offen offset:1024 lds
  s_mul_i32 s68, s56, 458752
  s_lshl_b32 s62, s85, 10
  s_add_u32 s68, s68, s62
  s_waitcnt vmcnt(10)
  ds_read_b64_tr_b16 a[0:1], v13 offset:0
  ds_read_b64_tr_b16 a[2:3], v13 offset:512
  ds_read_b64_tr_b16 a[4:5], v14 offset:0
  ds_read_b64_tr_b16 a[6:7], v14 offset:512
  s_waitcnt vmcnt(8)
  ds_read_b64_tr_b16 a[8:9], v13 offset:2048
  ds_read_b64_tr_b16 a[10:11], v13 offset:2560
  ds_read_b64_tr_b16 a[12:13], v14 offset:2048
  ds_read_b64_tr_b16 a[14:15], v14 offset:2560
  s_waitcnt lgkmcnt(4)
  s_add_u32 m0, s61, 0
  s_add_u32 s66, s66, 57344
  buffer_load_dwordx4 v10, s[52:55], s66 offen lds
  buffer_load_dwordx4 v11, s[52:55], s66 offen offset:1024 lds
  s_waitcnt vmcnt(8)
  ds_read_b64_tr_b16 a[16:17], v13 offset:4096
  ds_read_b64_tr_b16 a[18:19], v13 offset:4608
  ds_read_b64_tr_b16 a[20:21], v14 offset:4096
  ds_read_b64_tr_b16 a[22:23], v14 offset:4608
  s_waitcnt lgkmcnt(4)
  s_add_u32 m0, s61, 2048
  s_add_u32 s66, s66, 57344
  buffer_load_dwordx4 v10, s[52:55], s66 offen lds
  buffer_load_dwordx4 v11, s[52:55], s66 offen offset:1024 lds
  s_waitcnt vmcnt(8)
  ds_read_b64_tr_b16 a[24:25], v13 offset:6144
  ds_read_b64_tr_b16 a[26:27], v13 offset:6656
  ds_read_b64_tr_b16 a[28:29], v14 offset:6144
  ds_read_b64_tr_b16 a[30:31], v14 offset:6656
  s_waitcnt lgkmcnt(4)
  s_add_u32 m0, s61, 4096
  s_add_u32 s66, s66, 57344
  buffer_load_dwordx4 v10, s[52:55], s66 offen lds
  buffer_load_dwordx4 v11, s[52:55], s66 offen offset:1024 lds
  s_waitcnt vmcnt(8)
  ds_read_b64_tr_b16 a[32:33], v13 offset:8192
  ds_read_b64_tr_b16 a[34:35], v13 offset:8704
  ds_read_b64_tr_b16 a[36:37], v14 offset:8192
  ds_read_b64_tr_b16 a[38:39], v14 offset:8704
  s_waitcnt lgkmcnt(4)
  s_add_u32 m0, s61, 6144
  s_add_u32 s66, s66, 57344
  buffer_load_dwordx4 v10, s[52:55], s66 offen lds
  buffer_load_dwordx4 v11, s[52:55], s66 offen offset:1024 lds
  s_waitcnt vmcnt(8)
  ds_read_b64_tr_b16 a[40:41], v13 offset:10240
  ds_read_b64_tr_b16 a[42:43], v13 offset:10752
  ds_read_b64_tr_b16 a[44:45], v14 offset:10240
  ds_read_b64_tr_b16 a[46:47], v14 offset:10752
  s_waitcnt lgkmcnt(4)
  s_add_u32 m0, s61, 8192
  s_add_u32 s66, s66, 57344
  buffer_load_dwordx4 v10, s[52:55], s66 offen lds
  buffer_load_dwordx4 v11, s[52:55], s66 offen offset:1024 lds
  s_waitcnt vmcnt(8)
  ds_read_b64_tr_b16 a[48:49], v13 offset:0
  ds_read_b64_tr_b16 a[50:51], v13 offset:512
  ds_read_b64_tr_b16 a[52:53], v14 offset:0
  ds_read_b64_tr_b16 a[54:55], v14 offset:512
  s_waitcnt lgkmcnt(4)
  s_add_u32 m0, s61, 10240
  s_add_u32 s66, s66, 57344
  buffer_load_dwordx4 v10, s[52:55], s66 offen lds
  buffer_load_dwordx4 v11, s[52:55], s66 offen offset:1024 lds
  s_waitcnt vmcnt(8)
  ds_read_b64_tr_b16 a[56:57], v13 offset:2048
  ds_read_b64_tr_b16 a[58:59], v13 offset:2560
  ds_read_b64_tr_b16 a[60:61], v14 offset:2048
  ds_read_b64_tr_b16 a[62:63], v14 offset:2560
  s_waitcnt lgkmcnt(4)
  s_add_u32 m0, s61, 0
  s_add_u32 s66, s66, 57344
  buffer_load_dwordx4 v10, s[52:55], s66 offen lds
  buffer_load_dwordx4 v11, s[52:55], s66 offen offset:1024 lds
  s_waitcnt vmcnt(8)
  ds_read_b64_tr_b16 a[64:65], v13 offset:4096
  ds_read_b64_tr_b16 a[66:67], v13 offset:4608
  ds_read_b64_tr_b16 a[68:69], v14 offset:4096
  ds_read_b64_tr_b16 a[70:71], v14 offset:4608
  s_waitcnt lgkmcnt(4)
  s_add_u32 m0, s61, 2048
  s_add_u32 s66, s66, 57344
  buffer_load_dwordx4 v10, s[52:55], s66 offen lds
  buffer_load_dwordx4 v11, s[52:55], s66 offen offset:1024 lds
  s_waitcnt vmcnt(8)
  ds_read_b64_tr_b16 a[72:73], v13 offset:6144
  ds_read_b64_tr_b16 a[74:75], v13 offset:6656
  ds_read_b64_tr_b16 a[76:77], v14 offset:6144
  ds_read_b64_tr_b16 a[78:79], v14 offset:6656
  s_waitcnt lgkmcnt(4)
  s_add_u32 m0, s61, 4096
  s_add_u32 s66, s66, 57344
  buffer_load_dwordx4 v10, s[52:55], s66 offen lds
  buffer_load_dwordx4 v11, s[52:55], s66 offen offset:1024 lds
  s_waitcnt vmcnt(8)
  ds_read_b64_tr_b16 a[80:81], v13 offset:8192
  ds_read_b64_tr_b16 a[82:83], v13 offset:8704
  ds_read_b64_tr_b16 a[84:85], v14 offset:8192
  ds_read_b64_tr_b16 a[86:87], v14 offset:8704
  s_waitcnt lgkmcnt(4)
  s_add_u32 m0, s61, 6144
  s_add_u32 s66, s66, 57344
  buffer_load_dwordx4 v10, s[52:55], s66 offen lds
  buffer_load_dwordx4 v11, s[52:55], s66 offen offset:1024 lds
  s_waitcnt vmcnt(8)
  ds_read_b64_tr_b16 a[88:89], v13 offset:10240
  ds_read_b64_tr_b16 a[90:91], v13 offset:10752
  ds_read_b64_tr_b16 a[92:93], v14 offset:10240
  ds_read_b64_tr_b16 a[94:95], v14 offset:10752
  s_waitcnt lgkmcnt(4)
  s_add_u32 m0, s61, 8192
  s_add_u32 s66, s66, 57344
  buffer_load_dwordx4 v10, s[52:55], s66 offen lds
  buffer_load_dwordx4 v11, s[52:55], s66 offen offset:1024 lds
  s_waitcnt vmcnt(8)
  ds_read_b64_tr_b16 a[96:97], v13 offset:0
  ds_read_b64_tr_b16 a[98:99], v13 offset:512
  ds_read_b64_tr_b16 a[100:101], v14 offset:0
  ds_read_b64_tr_b16 a[102:103], v14 offset:512
  s_waitcnt lgkmcnt(4)
  s_add_u32 m0, s61, 10240
  s_add_u32 s66, s66, 57344
  buffer_load_dwordx4 v10, s[52:55], s66 offen lds
  buffer_load_dwordx4 v11, s[52:55], s66 offen offset:1024 lds
  s_waitcnt vmcnt(8)
  ds_read_b64_tr_b16 a[104:105], v13 offset:2048
  ds_read_b64_tr_b16 a[106:107], v13 offset:2560
  ds_read_b64_tr_b16 a[108:109], v14 offset:2048
  ds_read_b64_tr_b16 a[110:111], v14 offset:2560
  s_waitcnt lgkmcnt(4)
  s_add_u32 m0, s61, 0
  s_add_u32 s66, s66, 57344
  buffer_load_dwordx4 v10, s[52:55], s66 offen lds
  buffer_load_dwordx4 v11, s[52:55], s66 offen offset:1024 lds
  s_waitcnt vmcnt(8)
  ds_read_b64_tr_b16 a[112:113], v13 offset:4096
  ds_read_b64_tr_b16 a[114:115], v13 offset:4608
  ds_read_b64_tr_b16 a[116:117], v14 offset:4096
  ds_read_b64_tr_b16 a[118:119], v14 offset:4608
  s_waitcnt lgkmcnt(4)
  s_add_u32 m0, s61, 2048
  s_add_u32 s66, s66, 57344
  buffer_load_dwordx4 v10, s[52:55], s66 offen lds
  buffer_load_dwordx4 v11, s[52:55], s66 offen offset:1024 lds
  s_waitcnt vmcnt(8)
  ds_read_b64_tr_b16 a[120:121], v13 offset:6144
  ds_read_b64_tr_b16 a[122:123], v13 offset:6656
  ds_read_b64_tr_b16 a[124:125], v14 offset:6144
  ds_read_b64_tr_b16 a[126:127], v14 offset:6656
  s_waitcnt lgkmcnt(4)
  s_add_u32 m0, s61, 4096
  s_add_u32 s66, s66, 57344
  buffer_load_dwordx4 v10, s[52:55], s66 offen lds
  buffer_load_dwordx4 v11, s[52:55], s66 offen offset:1024 lds
  s_waitcnt vmcnt(8)
  ds_read_b64_tr_b16 a[128:129], v13 offset:8192
  ds_read_b64_tr_b16 a[130:131], v13 offset:8704
  ds_read_b64_tr_b16 a[132:133], v14 offset:8192
  ds_read_b64_tr_b16 a[134:135], v14 offset:8704
  s_waitcnt lgkmcnt(4)
  s_add_u32 m0, s61, 6144
  s_add_u32 s66, s66, 57344
  buffer_load_dwordx4 v10, s[52:55], s66 offen lds
  buffer_load_dwordx4 v11, s[52:55], s66 offen offset:1024 lds
  s_mov_b32 s44, s12
  s_mov_b32 s45, s13
  s_mov_b32 s46, 0x1c0000
  s_mov_b32 s47, 0x20000
  buffer_load_dwordx2 v[206:207], v202, s[44:47], s91 offen
  buffer_load_dwordx4 v[208:211], v200, s[44:47], s91 offen
  buffer_load_dwordx2 v[212:213], v201, s[44:47], s91 offen
  buffer_load_dwordx4 v[214:217], v200, s[44:47], s91 offen offset:1024
  s_waitcnt vmcnt(12)
  ds_read_b64_tr_b16 a[136:137], v13 offset:10240
  ds_read_b64_tr_b16 a[138:139], v13 offset:10752
  ds_read_b64_tr_b16 a[140:141], v14 offset:10240
  ds_read_b64_tr_b16 a[142:143], v14 offset:10752
  s_waitcnt lgkmcnt(4)
  s_add_u32 m0, s61, 8192
  s_add_u32 s66, s66, 57344
  buffer_load_dwordx4 v10, s[52:55], s66 offen lds
  buffer_load_dwordx4 v11, s[52:55], s66 offen offset:1024 lds
  s_waitcnt vmcnt(12)
  ds_read_b64_tr_b16 a[144:145], v13 offset:0
  ds_read_b64_tr_b16 a[146:147], v13 offset:512
  ds_read_b64_tr_b16 a[148:149], v14 offset:0
  ds_read_b64_tr_b16 a[150:151], v14 offset:512
  s_waitcnt lgkmcnt(4)
  s_add_u32 m0, s61, 10240
  s_add_u32 s66, s66, 57344
  buffer_load_dwordx4 v10, s[52:55], s66 offen lds
  buffer_load_dwordx4 v11, s[52:55], s66 offen offset:1024 lds
  s_waitcnt vmcnt(12)
  ds_read_b64_tr_b16 a[152:153], v13 offset:2048
  ds_read_b64_tr_b16 a[154:155], v13 offset:2560
  ds_read_b64_tr_b16 a[156:157], v14 offset:2048
  ds_read_b64_tr_b16 a[158:159], v14 offset:2560
  s_waitcnt lgkmcnt(4)
  s_add_u32 m0, s61, 0
  s_add_u32 s66, s66, 57344
  buffer_load_dwordx4 v10, s[52:55], s66 offen lds
  buffer_load_dwordx4 v11, s[52:55], s66 offen offset:1024 lds
  s_waitcnt vmcnt(12)
  ds_read_b64_tr_b16 a[160:161], v13 offset:4096
  ds_read_b64_tr_b16 a[162:163], v13 offset:4608
  ds_read_b64_tr_b16 a[164:165], v14 offset:4096
  ds_read_b64_tr_b16 a[166:167], v14 offset:4608
  s_waitcnt lgkmcnt(4)
  s_add_u32 m0, s61, 2048
  s_add_u32 s66, s66, 57344
  buffer_load_dwordx4 v10, s[52:55], s66 offen lds
  buffer_load_dwordx4 v11, s[52:55], s66 offen offset:1024 lds
  s_waitcnt vmcnt(12)
  ds_read_b64_tr_b16 a[168:169], v13 offset:6144
  ds_read_b64_tr_b16 a[170:171], v13 offset:6656
  ds_read_b64_tr_b16 a[172:173], v14 offset:6144
  ds_read_b64_tr_b16 a[174:175], v14 offset:6656
  s_waitcnt lgkmcnt(4)
  s_add_u32 m0, s61, 4096
  s_add_u32 s66, s66, 57344
  buffer_load_dwordx4 v10, s[52:55], s66 offen lds
  buffer_load_dwordx4 v11, s[52:55], s66 offen offset:1024 lds
  s_waitcnt vmcnt(8)
  ds_read_b64_tr_b16 a[176:177], v13 offset:8192
  ds_read_b64_tr_b16 a[178:179], v13 offset:8704
  ds_read_b64_tr_b16 a[180:181], v14 offset:8192
  ds_read_b64_tr_b16 a[182:183], v14 offset:8704
  s_waitcnt lgkmcnt(4)
  s_add_u32 m0, s61, 6144
  s_add_u32 s66, s66, 57344
  buffer_load_dwordx4 v10, s[52:55], s66 offen lds
  buffer_load_dwordx4 v11, s[52:55], s66 offen offset:1024 lds
  buffer_load_dword v250, v23, s[32:35], 0 offen sc1
  v_permlane32_swap_b32 v32, v34
  v_permlane32_swap_b32 v33, v35
  v_permlane32_swap_b32 v36, v38
  v_permlane32_swap_b32 v37, v39
  v_lshlrev_b32 v232, 16, v32
  v_and_b32 v233, s59, v32
  v_lshlrev_b32 v234, 16, v33
  v_and_b32 v235, s59, v33
  v_lshlrev_b32 v236, 16, v34
  v_and_b32 v237, s59, v34
  v_lshlrev_b32 v238, 16, v35
  v_and_b32 v239, s59, v35
  v_lshlrev_b32 v240, 16, v36
  v_and_b32 v241, s59, v36
  v_lshlrev_b32 v242, 16, v37
  v_and_b32 v243, s59, v37
  v_lshlrev_b32 v244, 16, v38
  v_and_b32 v245, s59, v38
  v_lshlrev_b32 v246, 16, v39
  v_and_b32 v247, s59, v39
  s_waitcnt vmcnt(9)
  ds_read_b64_tr_b16 a[184:185], v13 offset:10240
  ds_read_b64_tr_b16 a[186:187], v13 offset:10752
  ds_read_b64_tr_b16 a[188:189], v14 offset:10240
  ds_read_b64_tr_b16 a[190:191], v14 offset:10752
  s_waitcnt lgkmcnt(4)
  s_add_u32 m0, s61, 8192
  s_add_u32 s66, s66, 57344
  buffer_load_dwordx4 v10, s[52:55], s66 offen lds
  buffer_load_dwordx4 v11, s[52:55], s66 offen offset:1024 lds
  s_waitcnt vmcnt(9)
  ds_read_b64_tr_b16 a[192:193], v13 offset:0
  ds_read_b64_tr_b16 a[194:195], v13 offset:512
  ds_read_b64_tr_b16 a[196:197], v14 offset:0
  ds_read_b64_tr_b16 a[198:199], v14 offset:512
  s_waitcnt lgkmcnt(4)
  s_add_u32 m0, s61, 10240
  s_add_u32 s66, s66, 57344
  buffer_load_dwordx4 v10, s[52:55], s66 offen lds
  buffer_load_dwordx4 v11, s[52:55], s66 offen offset:1024 lds
  s_waitcnt vmcnt(9)
  ds_read_b64_tr_b16 a[200:201], v13 offset:2048
  ds_read_b64_tr_b16 a[202:203], v13 offset:2560
  ds_read_b64_tr_b16 a[204:205], v14 offset:2048
  ds_read_b64_tr_b16 a[206:207], v14 offset:2560
  s_waitcnt lgkmcnt(4)
  s_add_u32 m0, s61, 0
  s_add_u32 s66, s66, 57344
  buffer_load_dwordx4 v10, s[52:55], s66 offen lds
  buffer_load_dwordx4 v11, s[52:55], s66 offen offset:1024 lds
  s_waitcnt vmcnt(6)
  s_mov_b32 s60, 0
  s_branch L_P3_C
L_P3_L:
  s_sleep 2
  buffer_load_dword v250, v23, s[32:35], 0 offen sc1
  s_waitcnt vmcnt(0)
L_P3_C:
  v_cmp_ne_u32 vcc, v255, v250
  s_and_b64 exec, exec, vcc
  s_cbranch_scc0 L_P3_OK
  s_add_u32 s60, s60, 1
  s_cmp_lt_u32 s60, 0x8000
  s_cbranch_scc1 L_P3_L
L_P3_OK:
  s_mov_b64 exec, -1
  buffer_load_dwordx4 v[128:131], v16, s[32:35], s68 offen sc1
  buffer_load_dwordx4 v[132:135], v17, s[32:35], s68 offen sc1
  s_add_u32 s68, s68, 14336
  buffer_load_dwordx4 v[136:139], v16, s[32:35], s68 offen sc1
  buffer_load_dwordx4 v[140:143], v17, s[32:35], s68 offen sc1
  s_add_u32 s68, s68, 14336
  buffer_load_dwordx4 v[144:147], v16, s[32:35], s68 offen sc1
  buffer_load_dwordx4 v[148:151], v17, s[32:35], s68 offen sc1
  s_waitcnt vmcnt(4)
  v_mfma_f32_32x32x16_bf16 v[64:79], a[0:3], v[128:131], v[232:247]
  s_add_u32 s68, s68, 14336
  buffer_load_dwordx4 v[152:155], v16, s[32:35], s68 offen sc1
  s_lshr_b32 s62, s56, 1
  s_mul_i32 s92, s62, 21248
  s_add_u32 s92, s92, 114688
  v_mfma_f32_32x32x16_bf16 v[80:95], a[0:3], v[132:135], 0
  ds_read_b64_tr_b16 a[208:209], v13 offset:4096
  ds_read_b64_tr_b16 a[210:211], v13 offset:4608
  ds_read_b64_tr_b16 a[212:213], v14 offset:4096
  ds_read_b64_tr_b16 a[214:215], v14 offset:4608
  v_mfma_f32_32x32x16_bf16 v[96:111], a[4:7], v[128:131], 0
  buffer_load_dwordx4 v[156:159], v17, s[32:35], s68 offen sc1
  v_add_u32 v219, s92, v200
  ds_write_b128 v219, v[208:211] offset:64
  v_alignbit_b32 v220, v208, v207, 16
  v_mfma_f32_32x32x16_bf16 v[112:127], a[4:7], v[132:135], 0
  s_add_u32 s68, s68, 14336
  buffer_load_dwordx4 v[160:163], v16, s[32:35], s68 offen sc1
  buffer_load_dwordx4 v[164:167], v17, s[32:35], s68 offen sc1
  s_waitcnt vmcnt(6)
  v_mfma_f32_32x32x16_bf16 v[64:79], a[8:11], v[136:139], v[64:79]
  s_add_u32 s68, s68, 14336
  buffer_load_dwordx4 v[168:171], v16, s[32:35], s68 offen sc1
  v_alignbit_b32 v221, v209, v208, 16
  v_alignbit_b32 v222, v210, v209, 16
  v_alignbit_b32 v223, v211, v210, 16
  v_mfma_f32_32x32x16_bf16 v[80:95], a[8:11], v[140:143], v[80:95]
  s_waitcnt lgkmcnt(5)
  s_add_u32 m0, s61, 2048
  s_add_u32 s66, s66, 57344
  buffer_load_dwordx4 v10, s[52:55], s66 offen lds
  buffer_load_dwordx4 v11, s[52:55], s66 offen offset:1024 lds
  v_mfma_f32_32x32x16_bf16 v[96:111], a[12:15], v[136:139], v[96:111]
  buffer_load_dwordx4 v[172:175], v17, s[32:35], s68 offen sc1
  ds_write_b128 v219, v[220:223] offset:4224
  v_mov_b32 v224, v207
  v_mov_b32 v225, v208
  v_mfma_f32_32x32x16_bf16 v[112:127], a[12:15], v[140:143], v[112:127]
  s_add_u32 s68, s68, 14336
  buffer_load_dwordx4 v[176:179], v16, s[32:35], s68 offen sc1
  buffer_load_dwordx4 v[180:183], v17, s[32:35], s68 offen sc1
  s_waitcnt vmcnt(10)
  v_mfma_f32_32x32x16_bf16 v[64:79], a[16:19], v[144:147], v[64:79]
  s_add_u32 s68, s68, 14336
  buffer_load_dwordx4 v[184:187], v16, s[32:35], s68 offen sc1
  v_mov_b32 v226, v209
  v_mov_b32 v227, v210
  ds_write_b128 v219, v[224:227] offset:8384
  v_mfma_f32_32x32x16_bf16 v[80:95], a[16:19], v[148:151], v[80:95]
  ds_read_b64_tr_b16 a[216:217], v13 offset:6144
  ds_read_b64_tr_b16 a[218:219], v13 offset:6656
  ds_read_b64_tr_b16 a[220:221], v14 offset:6144
  ds_read_b64_tr_b16 a[222:223], v14 offset:6656
  v_mfma_f32_32x32x16_bf16 v[96:111], a[20:23], v[144:147], v[96:111]
  buffer_load_dwordx4 v[188:191], v17, s[32:35], s68 offen sc1
  v_alignbit_b32 v228, v207, v206, 16
  v_alignbit_b32 v229, v208, v207, 16
  v_alignbit_b32 v230, v209, v208, 16
  v_mfma_f32_32x32x16_bf16 v[112:127], a[20:23], v[148:151], v[112:127]
  s_add_u32 s68, s68, 14336
  buffer_load_dwordx4 v[128:131], v16, s[32:35], s68 offen sc1
  buffer_load_dwordx4 v[132:135], v17, s[32:35], s68 offen sc1
  s_waitcnt vmcnt(12)
  v_mfma_f32_32x32x16_bf16 v[64:79], a[24:27], v[152:155], v[64:79]
  s_add_u32 s68, s68, 14336
  buffer_load_dwordx4 v[136:139], v16, s[32:35], s68 offen sc1
  v_alignbit_b32 v231, v210, v209, 16
  ds_write_b128 v219, v[228:231] offset:12544
  ds_write_b128 v219, v[214:217] offset:1088
  v_mfma_f32_32x32x16_bf16 v[80:95], a[24:27], v[156:159], v[80:95]
  ds_read_b64_tr_b16 a[224:225], v13 offset:8192
  ds_read_b64_tr_b16 a[226:227], v13 offset:8704
  ds_read_b64_tr_b16 a[228:229], v14 offset:8192
  ds_read_b64_tr_b16 a[230:231], v14 offset:8704
  v_mfma_f32_32x32x16_bf16 v[96:111], a[28:31], v[152:155], v[96:111]
  buffer_load_dwordx4 v[140:143], v17, s[32:35], s68 offen sc1
  v_alignbit_b32 v220, v214, v213, 16
  v_alignbit_b32 v221, v215, v214, 16
  v_alignbit_b32 v222, v216, v215, 16
  v_mfma_f32_32x32x16_bf16 v[112:127], a[28:31], v[156:159], v[112:127]
  s_add_u32 s68, s68, 14336
  buffer_load_dwordx4 v[144:147], v16, s[32:35], s68 offen sc1
  buffer_load_dwordx4 v[148:151], v17, s[32:35], s68 offen sc1
  s_waitcnt vmcnt(14)
  v_mfma_f32_32x32x16_bf16 v[64:79], a[32:35], v[160:163], v[64:79]
  s_add_u32 s68, s68, 14336
  buffer_load_dwordx4 v[152:155], v16, s[32:35], s68 offen sc1
  v_alignbit_b32 v223, v217, v216, 16
  ds_write_b128 v219, v[220:223] offset:5248
  v_mov_b32 v224, v213
  v_mfma_f32_32x32x16_bf16 v[80:95], a[32:35], v[164:167], v[80:95]
  ds_read_b64_tr_b16 a[232:233], v13 offset:10240
  ds_read_b64_tr_b16 a[234:235], v13 offset:10752
  ds_read_b64_tr_b16 a[236:237], v14 offset:10240
  ds_read_b64_tr_b16 a[238:239], v14 offset:10752
  v_mfma_f32_32x32x16_bf16 v[96:111], a[36:39], v[160:163], v[96:111]
  buffer_load_dwordx4 v[156:159], v17, s[32:35], s68 offen sc1
  v_mov_b32 v225, v214
  v_mov_b32 v226, v215
  v_mov_b32 v227, v216
  v_mfma_f32_32x32x16_bf16 v[112:127], a[36:39], v[164:167], v[112:127]
  ds_read_b64_tr_b16 a[240:241], v13 offset:0
  ds_read_b64_tr_b16 a[242:243], v13 offset:512
  ds_read_b64_tr_b16 a[244:245], v14 offset:0
  ds_read_b64_tr_b16 a[246:247], v14 offset:512
  s_waitcnt vmcnt(12)
  v_mfma_f32_32x32x16_bf16 v[64:79], a[40:43], v[168:171], v[64:79]
  s_add_u32 s68, s68, 14336
  buffer_load_dwordx4 v[160:163], v16, s[32:35], s68 offen sc1
  ds_write_b128 v219, v[224:227] offset:9408
  v_alignbit_b32 v228, v213, v212, 16
  v_alignbit_b32 v229, v214, v213, 16
  v_mfma_f32_32x32x16_bf16 v[80:95], a[40:43], v[172:175], v[80:95]
  ds_read_b64_tr_b16 a[248:249], v13 offset:2048
  ds_read_b64_tr_b16 a[250:251], v13 offset:2560
  ds_read_b64_tr_b16 a[252:253], v14 offset:2048
  ds_read_b64_tr_b16 a[254:255], v14 offset:2560
  v_alignbit_b32 v230, v215, v214, 16
  v_alignbit_b32 v231, v216, v215, 16
  ds_write_b128 v219, v[228:231] offset:13568
  v_mfma_f32_32x32x16_bf16 v[96:111], a[44:47], v[168:171], v[96:111]
  buffer_load_dwordx4 v[164:167], v17, s[32:35], s68 offen sc1
  v_mov_b64 v[232:233], 0
  v_mov_b64 v[234:235], 0
  v_lshrrev_b32 v236, 2, v1
  v_mfma_f32_32x32x16_bf16 v[112:127], a[44:47], v[172:175], v[112:127]
  v_min_u32 v236, 4, v236
  v_mul_u32_u24 v236, 4160, v236
  v_lshlrev_b32 v237, 4, v1
  s_waitcnt vmcnt(12)
  v_mfma_f32_32x32x16_bf16 v[64:79], a[48:51], v[176:179], v[64:79]
  s_add_u32 s68, s68, 14336
  buffer_load_dwordx4 v[168:171], v16, s[32:35], s68 offen sc1
  v_subrev_u32 v238, 256, v237
  v_and_b32 v237, 48, v237
  v_cmp_gt_u32 vcc, 16, v1
  v_and_b32 v239, 15, v1
  v_lshrrev_b32 v240, 4, v1
  v_cndmask_b32 v237, v238, v237, vcc
  v_mfma_f32_32x32x16_bf16 v[80:95], a[48:51], v[180:183], v[80:95]
  v_add3_u32 v236, v236, v237, s92
  s_mov_b32 exec_hi, 0xffff
  ds_write_b128 v236, v[232:235]
  s_mov_b32 exec_hi, -1
  v_mfma_f32_32x32x16_bf16 v[96:111], a[52:55], v[176:179], v[96:111]
  buffer_load_dwordx4 v[172:175], v17, s[32:35], s68 offen sc1
  s_and_b32 s62, s56, 1
  s_lshl_b32 s63, s62, 8
  v_sub_u32 v241, 3, v239
  v_mfma_f32_32x32x16_bf16 v[112:127], a[52:55], v[180:183], v[112:127]
  v_and_b32 v241, 3, v241
  v_add3_u32 v192, v239, v241, 9
  v_lshlrev_b32 v242, 3, v240
  s_waitcnt vmcnt(12)
  v_mfma_f32_32x32x16_bf16 v[64:79], a[56:59], v[184:187], v[64:79]
  s_add_u32 s68, s68, 14336
  buffer_load_dwordx4 v[176:179], v16, s[32:35], s68 offen sc1
  v_sub_u32 v192, v192, v242
  v_mul_u32_u24 v241, 4160, v241
  v_lshl_add_u32 v192, v192, 1, v241
  v_mfma_f32_32x32x16_bf16 v[80:95], a[56:59], v[188:191], v[80:95]
  s_add_u32 s96, s92, s63
  v_add3_u32 v192, v192, s96, 64
  v_lshlrev_b32 v193, 5, v239
  v_mfma_f32_32x32x16_bf16 v[96:111], a[60:63], v[184:187], v[96:111]
  buffer_load_dwordx4 v[180:183], v17, s[32:35], s68 offen sc1
  v_lshl_add_u32 v193, v240, 4, v193
  s_sub_u32 s96, s92, s63
  s_add_u32 s96, s96, 17120
  v_mfma_f32_32x32x16_bf16 v[112:127], a[60:63], v[188:191], v[112:127]
  v_add_u32 v193, s96, v193
  v_lshlrev_b32 v194, 5, v239
  v_and_b32 v242, 1, v240
  s_waitcnt vmcnt(12)
  v_mfma_f32_32x32x16_bf16 v[64:79], a[64:67], v[128:131], v[64:79]
  s_add_u32 s68, s68, 14336
  buffer_load_dwordx4 v[184:187], v16, s[32:35], s68 offen sc1
  v_lshl_add_u32 v194, v242, 9, v194
  v_lshrrev_b32 v242, 1, v240
  v_lshl_add_u32 v194, v242, 4, v194
  v_mfma_f32_32x32x16_bf16 v[80:95], a[64:67], v[132:135], v[80:95]
  s_lshl_b32 s63, s62, 11
  s_add_u32 s69, s69, s63
  s_add_u32 s69, s69, 0x800000
  v_mfma_f32_32x32x16_bf16 v[96:111], a[68:71], v[128:131], v[96:111]
  buffer_load_dwordx4 v[188:191], v17, s[32:35], s68 offen sc1
  v_lshrrev_b32 v242, 3, v239
  s_lshl_b32 s62, s62, 3
  v_add3_u32 v242, v242, s62, 2
  v_mfma_f32_32x32x16_bf16 v[112:127], a[68:71], v[132:135], v[112:127]
  v_cmp_eq_u32 vcc, v242, v240
  v_and_b32 v243, 1, v239
  v_lshlrev_b32 v244, 16, v205
  v_cndmask_b32 v205, 0, v205, vcc
  s_waitcnt vmcnt(12)
  v_mfma_f32_32x32x16_bf16 v[64:79], a[72:75], v[136:139], v[64:79]
  s_add_u32 s68, s68, 14336
  buffer_load_dwordx4 v[128:131], v16, s[32:35], s68 offen sc1
  v_cndmask_b32 v244, 0, v244, vcc
  v_cmp_eq_u32 vcc, 0, v243
  v_bfe_u32 v245, v239, 1, 2
  s_nop 0
  v_cndmask_b32 v205, v205, v244, vcc
  v_mfma_f32_32x32x16_bf16 v[80:95], a[72:75], v[140:143], v[80:95]
  v_cmp_eq_u32 vcc, 3, v245
  s_nop 1
  v_cndmask_b32 v196, 0, v205, vcc
  v_mfma_f32_32x32x16_bf16 v[96:111], a[76:79], v[136:139], v[96:111]
  buffer_load_dwordx4 v[132:135], v17, s[32:35], s68 offen sc1
  v_cmp_eq_u32 vcc, 2, v245
  s_nop 1
  v_cndmask_b32 v197, 0, v205, vcc
  v_mfma_f32_32x32x16_bf16 v[112:127], a[76:79], v[140:143], v[112:127]
  v_cmp_eq_u32 vcc, 1, v245
  s_nop 1
  v_cndmask_b32 v198, 0, v205, vcc
  s_waitcnt vmcnt(12)
  v_mfma_f32_32x32x16_bf16 v[64:79], a[80:83], v[144:147], v[64:79]
  s_add_u32 s68, s68, 14336
  buffer_load_dwordx4 v[136:139], v16, s[32:35], s68 offen sc1
  v_cmp_eq_u32 vcc, 0, v245
  s_nop 1
  v_cndmask_b32 v199, 0, v205, vcc
  v_mfma_f32_32x32x16_bf16 v[80:95], a[80:83], v[148:151], v[80:95]
  v_mfma_f32_32x32x16_bf16 v[96:111], a[84:87], v[144:147], v[96:111]
  buffer_load_dwordx4 v[140:143], v17, s[32:35], s68 offen sc1
  v_mfma_f32_32x32x16_bf16 v[112:127], a[84:87], v[148:151], v[112:127]
  s_waitcnt vmcnt(12)
  v_mfma_f32_32x32x16_bf16 v[64:79], a[88:91], v[152:155], v[64:79]
  s_add_u32 s68, s68, 14336
  buffer_load_dwordx4 v[144:147], v16, s[32:35], s68 offen sc1
  v_mfma_f32_32x32x16_bf16 v[80:95], a[88:91], v[156:159], v[80:95]
  v_mfma_f32_32x32x16_bf16 v[96:111], a[92:95], v[152:155], v[96:111]
  buffer_load_dwordx4 v[148:151], v17, s[32:35], s68 offen sc1
  v_mfma_f32_32x32x16_bf16 v[112:127], a[92:95], v[156:159], v[112:127]
  s_waitcnt vmcnt(12)
  v_mfma_f32_32x32x16_bf16 v[64:79], a[96:99], v[160:163], v[64:79]
  s_add_u32 s68, s68, 14336
  buffer_load_dwordx4 v[152:155], v16, s[32:35], s68 offen sc1
  v_mfma_f32_32x32x16_bf16 v[80:95], a[96:99], v[164:167], v[80:95]
  v_mfma_f32_32x32x16_bf16 v[96:111], a[100:103], v[160:163], v[96:111]
  buffer_load_dwordx4 v[156:159], v17, s[32:35], s68 offen sc1
  v_mfma_f32_32x32x16_bf16 v[112:127], a[100:103], v[164:167], v[112:127]
  s_waitcnt vmcnt(12)
  v_mfma_f32_32x32x16_bf16 v[64:79], a[104:107], v[168:171], v[64:79]
  s_add_u32 s68, s68, 14336
  buffer_load_dwordx4 v[160:163], v16, s[32:35], s68 offen sc1
  v_mfma_f32_32x32x16_bf16 v[80:95], a[104:107], v[172:175], v[80:95]
  v_mfma_f32_32x32x16_bf16 v[96:111], a[108:111], v[168:171], v[96:111]
  buffer_load_dwordx4 v[164:167], v17, s[32:35], s68 offen sc1
  v_mfma_f32_32x32x16_bf16 v[112:127], a[108:111], v[172:175], v[112:127]
  s_waitcnt vmcnt(12)
  v_mfma_f32_32x32x16_bf16 v[64:79], a[112:115], v[176:179], v[64:79]
  s_add_u32 s68, s68, 14336
  buffer_load_dwordx4 v[168:171], v16, s[32:35], s68 offen sc1
  v_mfma_f32_32x32x16_bf16 v[80:95], a[112:115], v[180:183], v[80:95]
  v_mfma_f32_32x32x16_bf16 v[96:111], a[116:119], v[176:179], v[96:111]
  buffer_load_dwordx4 v[172:175], v17, s[32:35], s68 offen sc1
  v_mfma_f32_32x32x16_bf16 v[112:127], a[116:119], v[180:183], v[112:127]
  s_waitcnt vmcnt(12)
  v_mfma_f32_32x32x16_bf16 v[64:79], a[120:123], v[184:187], v[64:79]
  s_add_u32 s68, s68, 14336
  buffer_load_dwordx4 v[176:179], v16, s[32:35], s68 offen sc1
  v_mfma_f32_32x32x16_bf16 v[80:95], a[120:123], v[188:191], v[80:95]
  v_mfma_f32_32x32x16_bf16 v[96:111], a[124:127], v[184:187], v[96:111]
  buffer_load_dwordx4 v[180:183], v17, s[32:35], s68 offen sc1
  v_mfma_f32_32x32x16_bf16 v[112:127], a[124:127], v[188:191], v[112:127]
  s_waitcnt vmcnt(12)
  v_mfma_f32_32x32x16_bf16 v[64:79], a[128:131], v[128:131], v[64:79]
  s_add_u32 s68, s68, 14336
  buffer_load_dwordx4 v[184:187], v16, s[32:35], s68 offen sc1
  v_mfma_f32_32x32x16_bf16 v[80:95], a[128:131], v[132:135], v[80:95]
  v_mfma_f32_32x32x16_bf16 v[96:111], a[132:135], v[128:131], v[96:111]
  buffer_load_dwordx4 v[188:191], v17, s[32:35], s68 offen sc1
  v_mfma_f32_32x32x16_bf16 v[112:127], a[132:135], v[132:135], v[112:127]
  s_waitcnt vmcnt(12)
  v_mfma_f32_32x32x16_bf16 v[64:79], a[136:139], v[136:139], v[64:79]
  s_add_u32 s68, s68, 14336
  buffer_load_dwordx4 v[128:131], v16, s[32:35], s68 offen sc1
  v_mfma_f32_32x32x16_bf16 v[80:95], a[136:139], v[140:143], v[80:95]
  v_mfma_f32_32x32x16_bf16 v[96:111], a[140:143], v[136:139], v[96:111]
  buffer_load_dwordx4 v[132:135], v17, s[32:35], s68 offen sc1
  v_mfma_f32_32x32x16_bf16 v[112:127], a[140:143], v[140:143], v[112:127]
  s_waitcnt vmcnt(12)
  v_mfma_f32_32x32x16_bf16 v[64:79], a[144:147], v[144:147], v[64:79]
  s_add_u32 s68, s68, 14336
  buffer_load_dwordx4 v[136:139], v16, s[32:35], s68 offen sc1
  v_mfma_f32_32x32x16_bf16 v[80:95], a[144:147], v[148:151], v[80:95]
  v_mfma_f32_32x32x16_bf16 v[96:111], a[148:151], v[144:147], v[96:111]
  buffer_load_dwordx4 v[140:143], v17, s[32:35], s68 offen sc1
  v_mfma_f32_32x32x16_bf16 v[112:127], a[148:151], v[148:151], v[112:127]
  s_waitcnt vmcnt(12)
  v_mfma_f32_32x32x16_bf16 v[64:79], a[152:155], v[152:155], v[64:79]
  s_add_u32 s68, s68, 14336
  buffer_load_dwordx4 v[144:147], v16, s[32:35], s68 offen sc1
  v_mfma_f32_32x32x16_bf16 v[80:95], a[152:155], v[156:159], v[80:95]
  v_mfma_f32_32x32x16_bf16 v[96:111], a[156:159], v[152:155], v[96:111]
  buffer_load_dwordx4 v[148:151], v17, s[32:35], s68 offen sc1
  v_mfma_f32_32x32x16_bf16 v[112:127], a[156:159], v[156:159], v[112:127]
  s_waitcnt vmcnt(12)
  v_mfma_f32_32x32x16_bf16 v[64:79], a[160:163], v[160:163], v[64:79]
  s_add_u32 s68, s68, 14336
  buffer_load_dwordx4 v[152:155], v16, s[32:35], s68 offen sc1
  v_mfma_f32_32x32x16_bf16 v[80:95], a[160:163], v[164:167], v[80:95]
  v_mfma_f32_32x32x16_bf16 v[96:111], a[164:167], v[160:163], v[96:111]
  buffer_load_dwordx4 v[156:159], v17, s[32:35], s68 offen sc1
  v_mfma_f32_32x32x16_bf16 v[112:127], a[164:167], v[164:167], v[112:127]
  s_waitcnt vmcnt(12)
  v_mfma_f32_32x32x16_bf16 v[64:79], a[168:171], v[168:171], v[64:79]
  s_add_u32 s68, s68, 14336
  buffer_load_dwordx4 v[160:163], v16, s[32:35], s68 offen sc1
  v_mfma_f32_32x32x16_bf16 v[80:95], a[168:171], v[172:175], v[80:95]
  v_mfma_f32_32x32x16_bf16 v[96:111], a[172:175], v[168:171], v[96:111]
  buffer_load_dwordx4 v[164:167], v17, s[32:35], s68 offen sc1
  v_mfma_f32_32x32x16_bf16 v[112:127], a[172:175], v[172:175], v[112:127]
  s_waitcnt vmcnt(12)
  buffer_load_dword v250, v24, s[32:35], 0 offen sc1
  v_mfma_f32_32x32x16_bf16 v[64:79], a[176:179], v[176:179], v[64:79]
  s_add_u32 s68, s68, 14336
  buffer_load_dwordx4 v[168:171], v16, s[32:35], s68 offen sc1
  v_mfma_f32_32x32x16_bf16 v[80:95], a[176:179], v[180:183], v[80:95]
  v_mfma_f32_32x32x16_bf16 v[96:111], a[180:183], v[176:179], v[96:111]
  buffer_load_dwordx4 v[172:175], v17, s[32:35], s68 offen sc1
  v_mfma_f32_32x32x16_bf16 v[112:127], a[180:183], v[180:183], v[112:127]
  s_waitcnt vmcnt(13)
  v_mfma_f32_32x32x16_bf16 v[64:79], a[184:187], v[184:187], v[64:79]
  s_add_u32 s68, s68, 14336
  buffer_load_dwordx4 v[176:179], v16, s[32:35], s68 offen sc1
  v_mfma_f32_32x32x16_bf16 v[80:95], a[184:187], v[188:191], v[80:95]
  v_mfma_f32_32x32x16_bf16 v[96:111], a[188:191], v[184:187], v[96:111]
  buffer_load_dwordx4 v[180:183], v17, s[32:35], s68 offen sc1
  v_mfma_f32_32x32x16_bf16 v[112:127], a[188:191], v[188:191], v[112:127]
  s_waitcnt vmcnt(13)
  v_mfma_f32_32x32x16_bf16 v[64:79], a[192:195], v[128:131], v[64:79]
  s_add_u32 s68, s68, 14336
  buffer_load_dwordx4 v[184:187], v16, s[32:35], s68 offen sc1
  v_mfma_f32_32x32x16_bf16 v[80:95], a[192:195], v[132:135], v[80:95]
  v_mfma_f32_32x32x16_bf16 v[96:111], a[196:199], v[128:131], v[96:111]
  buffer_load_dwordx4 v[188:191], v17, s[32:35], s68 offen sc1
  v_mfma_f32_32x32x16_bf16 v[112:127], a[196:199], v[132:135], v[112:127]
  s_waitcnt vmcnt(13)
  s_waitcnt vmcnt(6)
  s_mov_b32 s60, 0
  s_branch L_P4_C
L_P4_L:
  s_sleep 2
  buffer_load_dword v250, v24, s[32:35], 0 offen sc1
  s_waitcnt vmcnt(0)
L_P4_C:
  v_cmp_ne_u32 vcc, v255, v250
  s_and_b64 exec, exec, vcc
  s_cbranch_scc0 L_P4_OK
  s_add_u32 s60, s60, 1
  s_cmp_lt_u32 s60, 0x8000
  s_cbranch_scc1 L_P4_L
L_P4_OK:
  s_mov_b64 exec, -1
  s_and_b32 s62, s56, 1
  s_lshl_b32 s62, s62, 11
  s_add_u32 s62, s62, s92
  s_add_u32 m0, s62, 17152
  s_sub_u32 s63, s69, 0x600000
  v_lshlrev_b32 v4, 4, v1
  buffer_load_dwordx4 v4, s[32:35], s63 offen sc1 lds
  buffer_load_dwordx4 v4, s[32:35], s63 offen offset:1024 sc1 lds
  v_mfma_f32_32x32x16_bf16 v[64:79], a[200:203], v[136:139], v[64:79]
  v_mfma_f32_32x32x16_bf16 v[80:95], a[200:203], v[140:143], v[80:95]
  v_mfma_f32_32x32x16_bf16 v[96:111], a[204:207], v[136:139], v[96:111]
  v_mfma_f32_32x32x16_bf16 v[112:127], a[204:207], v[140:143], v[112:127]
  s_waitcnt lgkmcnt(14)
  s_mov_b32 s36, s4
  s_mov_b32 s37, s5
  s_mov_b32 s38, 0x1c0000
  s_mov_b32 s39, 0x20000
  buffer_load_dwordx4 v[40:43], v195, s[36:39], s88 offen offset:0
  buffer_load_dwordx4 v[44:47], v195, s[36:39], s88 offen offset:32
  s_mov_b32 s40, s24
  s_mov_b32 s41, s25
  s_mov_b32 s42, 0x1000
  s_mov_b32 s43, 0x20000
  buffer_load_ushort v48, v22, s[40:43], 0 offen
  v_mfma_f32_32x32x16_bf16 v[64:79], a[208:211], v[144:147], v[64:79]
  v_mfma_f32_32x32x16_bf16 v[80:95], a[208:211], v[148:151], v[80:95]
  v_mfma_f32_32x32x16_bf16 v[96:111], a[212:215], v[144:147], v[96:111]
  v_mfma_f32_32x32x16_bf16 v[112:127], a[212:215], v[148:151], v[112:127]
  s_waitcnt lgkmcnt(14)
  v_mfma_f32_32x32x16_bf16 v[64:79], a[216:219], v[152:155], v[64:79]
  v_mfma_f32_32x32x16_bf16 v[80:95], a[216:219], v[156:159], v[80:95]
  v_mfma_f32_32x32x16_bf16 v[96:111], a[220:223], v[152:155], v[96:111]
  v_mfma_f32_32x32x16_bf16 v[112:127], a[220:223], v[156:159], v[112:127]
  s_waitcnt lgkmcnt(2)
  v_mfma_f32_32x32x16_bf16 v[112:127], a[228:231], v[164:167], v[112:127]
  s_waitcnt vmcnt(9)
  v_mfma_f32_32x32x16_bf16 v[112:127], a[236:239], v[172:175], v[112:127]
  s_waitcnt vmcnt(7)
  v_mfma_f32_32x32x16_bf16 v[112:127], a[244:247], v[180:183], v[112:127]
  s_waitcnt vmcnt(5)
  v_mfma_f32_32x32x16_bf16 v[112:127], a[252:255], v[188:191], v[112:127]
  v_mfma_f32_32x32x16_bf16 v[96:111], a[228:231], v[160:163], v[96:111]
  v_mfma_f32_32x32x16_bf16 v[96:111], a[236:239], v[168:171], v[96:111]
  s_nop 9
  ds_write_b128 v20, v[112:115] offset:0
  ds_write_b128 v20, v[116:119] offset:1024
  ds_write_b128 v20, v[120:123] offset:2048
  ds_write_b128 v20, v[124:127] offset:3072
  v_mfma_f32_32x32x16_bf16 v[96:111], a[244:247], v[176:179], v[96:111]
  v_mfma_f32_32x32x16_bf16 v[96:111], a[252:255], v[184:187], v[96:111]
  v_mfma_f32_32x32x16_bf16 v[80:95], a[224:227], v[164:167], v[80:95]
  v_mfma_f32_32x32x16_bf16 v[80:95], a[232:235], v[172:175], v[80:95]
  s_nop 9
  ds_write_b128 v19, v[96:99] offset:0
  ds_write_b128 v19, v[100:103] offset:1024
  ds_write_b128 v19, v[104:107] offset:2048
  ds_write_b128 v19, v[108:111] offset:3072
  v_mfma_f32_32x32x16_bf16 v[80:95], a[240:243], v[180:183], v[80:95]
  v_mfma_f32_32x32x16_bf16 v[80:95], a[248:251], v[188:191], v[80:95]
  v_mfma_f32_32x32x16_bf16 v[64:79], a[224:227], v[160:163], v[64:79]
  v_mfma_f32_32x32x16_bf16 v[64:79], a[232:235], v[168:171], v[64:79]
  s_nop 9
  ds_write_b128 v18, v[80:83] offset:0
  ds_write_b128 v18, v[84:87] offset:1024
  ds_write_b128 v18, v[88:91] offset:2048
  ds_write_b128 v18, v[92:95] offset:3072
  v_mfma_f32_32x32x16_bf16 v[64:79], a[240:243], v[176:179], v[64:79]
  v_mfma_f32_32x32x16_bf16 v[64:79], a[248:251], v[184:187], v[64:79]
  s_mov_b32 s62, 0xbdd2d3e8
  v_mov_b32 v52, 0xc0135761
  s_lshr_b32 s63, s56, 1
  s_lshl_b32 s64, s84, 3
  s_lshl_b32 s63, s63, 2
  s_add_u32 s64, s64, s63
  s_mul_i32 s64, s64, 7168
  s_lshl_b32 s63, s85, 10
  s_add_u32 s64, s64, s63
  s_add_u32 s64, s64, 0x500000
  s_add_u32 s65, s64, 14336
  s_add_u32 m0, s61, 0
  s_nop 0
  buffer_load_dwordx4 v8, s[48:51], s67 offen lds
  buffer_load_dwordx4 v9, s[48:51], s67 offen offset:1024 lds
  s_add_u32 m0, s61, 2048
  s_add_u32 s67, s67, 65536
  buffer_load_dwordx4 v8, s[48:51], s67 offen lds
  buffer_load_dwordx4 v9, s[48:51], s67 offen offset:1024 lds
  s_waitcnt vmcnt(7)
  s_waitcnt lgkmcnt(0)
  s_barrier
  ds_read_b128 v[80:83], v15 offset:4096
  ds_read_b128 v[96:99], v15 offset:8192
  ds_read_b128 v[112:115], v15 offset:12288
  ds_read_b128 v[84:87], v15 offset:5120
  ds_read_b128 v[100:103], v15 offset:9216
  ds_read_b128 v[116:119], v15 offset:13312
  ds_read_b128 v[88:91], v15 offset:6144
  ds_read_b128 v[104:107], v15 offset:10240
  ds_read_b128 v[120:123], v15 offset:14336
  ds_read_b128 v[92:95], v15 offset:7168
  ds_read_b128 v[108:111], v15 offset:11264
  ds_read_b128 v[124:127], v15 offset:15360
  s_add_u32 m0, s61, 4096
  s_add_u32 s67, s67, 65536
  buffer_load_dwordx4 v8, s[48:51], s67 offen lds
  buffer_load_dwordx4 v9, s[48:51], s67 offen offset:1024 lds
  s_add_u32 m0, s61, 6144
  s_add_u32 s67, s67, 65536
  buffer_load_dwordx4 v8, s[48:51], s67 offen lds
  buffer_load_dwordx4 v9, s[48:51], s67 offen offset:1024 lds
  buffer_load_dwordx2 v[50:51], v49, s[32:35], 0 offen sc1
  s_waitcnt lgkmcnt(10)
  v_pk_add_f32 v[80:81], v[80:81], v[96:97]
  v_pk_add_f32 v[82:83], v[82:83], v[98:99]
  s_waitcnt lgkmcnt(9)
  v_pk_add_f32 v[64:65], v[64:65], v[112:113]
  v_pk_add_f32 v[66:67], v[66:67], v[114:115]
  v_pk_add_f32 v[64:65], v[64:65], v[80:81]
  v_pk_add_f32 v[66:67], v[66:67], v[82:83]
  s_waitcnt lgkmcnt(7)
  v_pk_add_f32 v[84:85], v[84:85], v[100:101]
  v_pk_add_f32 v[86:87], v[86:87], v[102:103]
  s_waitcnt lgkmcnt(6)
  v_pk_add_f32 v[68:69], v[68:69], v[116:117]
  v_pk_add_f32 v[70:71], v[70:71], v[118:119]
  v_pk_add_f32 v[68:69], v[68:69], v[84:85]
  v_pk_add_f32 v[70:71], v[70:71], v[86:87]
  s_call_b64 s[30:31], L_GELU
  buffer_store_dwordx4 v[32:35], v16, s[32:35], s64 offen sc1
  s_waitcnt lgkmcnt(4)
  v_pk_add_f32 v[88:89], v[88:89], v[104:105]
  v_pk_add_f32 v[90:91], v[90:91], v[106:107]
  s_waitcnt lgkmcnt(3)
  v_pk_add_f32 v[72:73], v[72:73], v[120:121]
  v_pk_add_f32 v[74:75], v[74:75], v[122:123]
  v_pk_add_f32 v[72:73], v[72:73], v[88:89]
  v_pk_add_f32 v[74:75], v[74:75], v[90:91]
  s_waitcnt lgkmcnt(1)
  v_pk_add_f32 v[92:93], v[92:93], v[108:109]
  v_pk_add_f32 v[94:95], v[94:95], v[110:111]
  s_waitcnt lgkmcnt(0)
  v_pk_add_f32 v[76:77], v[76:77], v[124:125]
  v_pk_add_f32 v[78:79], v[78:79], v[126:127]
  v_pk_add_f32 v[76:77], v[76:77], v[92:93]
  v_pk_add_f32 v[78:79], v[78:79], v[94:95]
  v_mov_b64 v[64:65], v[72:73]
  v_mov_b64 v[66:67], v[74:75]
  v_mov_b64 v[68:69], v[76:77]
  v_mov_b64 v[70:71], v[78:79]
  s_call_b64 s[30:31], L_GELU
  buffer_store_dwordx4 v[32:35], v16, s[32:35], s65 offen sc1
  s_lshl_b32 s96, s82, 2
  s_add_u32 s96, s96, s56
  s_lshl_b32 s96, s96, 7
  s_add_u32 s96, s96, 0xa10000
  s_branch L_MID
L_GELU:
  v_pk_mul_f32 v[56:57], v[64:65], v[64:65]
  v_pk_mul_f32 v[58:59], v[66:67], v[66:67]
  v_pk_mul_f32 v[60:61], v[68:69], v[68:69]
  v_pk_mul_f32 v[62:63], v[70:71], v[70:71]
  v_pk_fma_f32 v[56:57], v[56:57], s[62:63], v[52:53] op_sel_hi:[1,0,0]
  v_pk_fma_f32 v[58:59], v[58:59], s[62:63], v[52:53] op_sel_hi:[1,0,0]
  v_pk_fma_f32 v[60:61], v[60:61], s[62:63], v[52:53] op_sel_hi:[1,0,0]
  v_pk_fma_f32 v[62:63], v[62:63], s[62:63], v[52:53] op_sel_hi:[1,0,0]
  v_pk_mul_f32 v[56:57], v[56:57], v[64:65]
  v_pk_mul_f32 v[58:59], v[58:59], v[66:67]
  v_pk_mul_f32 v[60:61], v[60:61], v[68:69]
  v_pk_mul_f32 v[62:63], v[62:63], v[70:71]
  v_exp_f32 v56, v56
  v_exp_f32 v57, v57
  v_exp_f32 v58, v58
  v_exp_f32 v59, v59
  v_exp_f32 v60, v60
  v_exp_f32 v61, v61
  v_exp_f32 v62, v62
  v_exp_f32 v63, v63
  v_pk_add_f32 v[56:57], v[56:57], 1.0 op_sel_hi:[1,0]
  v_pk_add_f32 v[58:59], v[58:59], 1.0 op_sel_hi:[1,0]
  v_pk_add_f32 v[60:61], v[60:61], 1.0 op_sel_hi:[1,0]
  v_pk_add_f32 v[62:63], v[62:63], 1.0 op_sel_hi:[1,0]
  v_rcp_f32 v56, v56
  v_rcp_f32 v57, v57
  v_rcp_f32 v58, v58
  v_rcp_f32 v59, v59
  v_rcp_f32 v60, v60
  v_rcp_f32 v61, v61
  v_rcp_f32 v62, v62
  v_rcp_f32 v63, v63
  v_pk_mul_f32 v[56:57], v[56:57], v[64:65]
  v_pk_mul_f32 v[58:59], v[58:59], v[66:67]
  v_pk_mul_f32 v[60:61], v[60:61], v[68:69]
  v_pk_mul_f32 v[62:63], v[62:63], v[70:71]
  v_cvt_pk_bf16_f32 v32, v56, v57
  v_cvt_pk_bf16_f32 v33, v58, v59
  v_cvt_pk_bf16_f32 v34, v60, v61
  v_cvt_pk_bf16_f32 v35, v62, v63
  s_nop 1
  v_permlane32_swap_b32 v32, v34
  v_permlane32_swap_b32 v33, v35
  s_setpc_b64 s[30:31]
L_NOG1:
  s_and_b32 s72, s75, 3
  s_mul_i32 s72, s72, 28
  s_lshr_b32 s63, s75, 2
  s_add_u32 s72, s72, s63
  s_lshl_b32 s72, s72, 16
  s_lshl_b32 s63, s57, 9
  s_add_u32 s72, s72, s63
  v_lshrrev_b32 v29, 2, v1
  v_lshlrev_b32 v29, 12, v29
  v_and_b32 v31, 3, v1
  v_lshl_add_u32 v29, v31, 7, v29
  s_mov_b32 s44, s12
  s_mov_b32 s45, s13
  s_mov_b32 s46, 0x1c0000
  s_mov_b32 s47, 0x20000
  s_lshl_b32 s62, s75, 3
  s_add_u32 s62, s62, s57
  s_lshl_b32 s62, s62, 13
  s_min_u32 s62, s62, 1835008
  v_lshlrev_b32 v30, 7, v1
  buffer_load_dword v253, v30, s[44:47], s62 offen
  s_lshr_b32 s62, s57, 1
  s_mul_i32 s62, s62, 7
  s_and_b32 s63, s57, 1
  s_lshl_b32 s63, s63, 2
  s_add_u32 s62, s62, s63
  s_add_u32 s62, s62, s58
  s_sub_u32 s77, s62, 25
  s_lshl_b32 s62, s57, 2
  s_add_u32 s62, s62, s58
  s_cmp_ge_u32 s58, 28
  s_cselect_b32 s77, s62, s77
  s_mul_i32 s93, s77, 9363
  s_lshr_b32 s93, s93, 16
  s_mul_i32 s94, s93, 7
  s_sub_u32 s94, s77, s94
  s_lshl_b32 s93, s93, 2
  s_add_u32 s93, s93, s56
  v_and_b32 v63, 7, v1
  s_lshl_b32 s64, s93, 3
  v_add_u32 v64, s64, v2
  s_lshl_b32 s65, s94, 3
  v_add_u32 v65, s65, v63
  v_mul_u32_u24 v66, 7168, v64
  v_lshl_add_u32 v66, v65, 4, v66
  v_add_u32 v67, 3584, v66
  v_subrev_u32 v68, 2688, v66
  v_mov_b32 v69, 0x80000000
  v_cmp_eq_u32 vcc, 0, v64
  v_lshlrev_b32 v71, 6, v65
  s_lshl_b32 s63, s56, 13
  v_cndmask_b32 v68, v68, v69, vcc
  s_mov_b32 s36, s6
  s_mov_b32 s37, s7
  s_mov_b32 s38, 0x1c0000
  s_mov_b32 s39, 0x20000
  s_mov_b32 s40, s8
  s_mov_b32 s41, s9
  s_mov_b32 s42, 0x1c0000
  s_mov_b32 s43, 0x20000
  s_mov_b32 s44, s10
  s_mov_b32 s45, s11
  s_mov_b32 s46, 0xe00
  s_mov_b32 s47, 0x20000
  s_nop 1
  s_waitcnt vmcnt(1)
  v_add_u32 v255, 1, v255
  s_barrier
  s_cmp_lg_u32 s56, 0
  s_cbranch_scc1 L_FA5
  v_mov_b32 v249, s96
  s_mov_b64 exec, 1
  buffer_store_dword v255, v249, s[32:35], 0 offen sc1
  s_mov_b64 exec, -1
L_FA5:
  buffer_load_dwordx4 v[88:91], v68, s[36:39], 0 offen offset:0
  buffer_load_dwordx4 v[92:95], v68, s[36:39], 0 offen offset:896
  buffer_load_dwordx4 v[96:99], v68, s[36:39], 0 offen offset:1792
  buffer_load_dwordx4 v[100:103], v66, s[36:39], 0 offen offset:0
  buffer_load_dwordx4 v[104:107], v66, s[36:39], 0 offen offset:896
  buffer_load_dwordx4 v[108:111], v66, s[36:39], 0 offen offset:1792
  buffer_load_dwordx4 v[112:115], v66, s[36:39], 0 offen offset:2688
  buffer_load_dwordx4 v[132:135], v66, s[40:43], 0 offen offset:0
  buffer_load_dwordx4 v[136:139], v66, s[40:43], 0 offen offset:896
  buffer_load_dwordx4 v[140:143], v66, s[40:43], 0 offen offset:1792
  buffer_load_dwordx4 v[144:147], v66, s[40:43], 0 offen offset:2688
  buffer_load_dwordx4 v[72:75], v71, s[44:47], 0 offen offset:0
  buffer_load_dwordx4 v[76:79], v71, s[44:47], 0 offen offset:16
  buffer_load_dwordx4 v[80:83], v71, s[44:47], 0 offen offset:32
  buffer_load_dwordx4 v[84:87], v71, s[44:47], 0 offen offset:48
  buffer_load_dwordx4 v[116:119], v67, s[36:39], 0 offen offset:0
  buffer_load_dwordx4 v[120:123], v67, s[36:39], 0 offen offset:896
  buffer_load_dwordx4 v[124:127], v67, s[36:39], 0 offen offset:1792
  buffer_load_dwordx4 v[128:131], v67, s[36:39], 0 offen offset:2688
  buffer_load_dwordx4 v[148:151], v67, s[40:43], 0 offen offset:0
  buffer_load_dwordx4 v[152:155], v67, s[40:43], 0 offen offset:896
  buffer_load_dwordx4 v[156:159], v67, s[40:43], 0 offen offset:1792
  buffer_load_dwordx4 v[160:163], v67, s[40:43], 0 offen offset:2688
  v_lshrrev_b32 v30, 4, v1
  v_lshlrev_b32 v30, 6, v30
  v_bfe_u32 v31, v1, 3, 1
  v_add_u32 v30, v30, v31
  v_mul_u32_u24 v30, 7168, v30
  v_and_b32 v31, 7, v1
  v_lshl_add_u32 v30, v31, 7, v30
  s_mul_i32 s63, s75, 9363
  s_lshr_b32 s63, s63, 16
  s_mul_i32 s62, s63, 7
  s_sub_u32 s62, s75, s62
  s_lshl_b32 s62, s62, 10
  s_mul_i32 s63, s63, 14336
  s_add_u32 s62, s62, s63
  s_add_u32 s63, s62, 0
  s_cmp_lt_u32 s75, 28
  s_cselect_b32 s63, s63, s34
  buffer_load_dword v253, v30, s[32:35], s63 offen sc1
  s_add_u32 s63, s62, 57344
  s_cmp_lt_u32 s75, 28
  s_cselect_b32 s63, s63, s34
  buffer_load_dword v253, v30, s[32:35], s63 offen sc1
  s_add_u32 s63, s62, 114688
  s_cmp_lt_u32 s75, 28
  s_cselect_b32 s63, s63, s34
  buffer_load_dword v253, v30, s[32:35], s63 offen sc1
  s_lshl_b32 s63, s56, 13
  s_add_u32 s63, s63, 16384
  v_xor_b32 v71, v2, v63
  v_lshlrev_b32 v71, 4, v71
  v_lshl_add_u32 v71, v63, 10, v71
  v_add_u32 v71, s63, v71
  v_lshlrev_b32 v60, 4, v1
  v_add_u32 v60, s63, v60
  v_lshlrev_b32 v61, 4, v63
  v_lshl_add_u32 v61, v2, 12, v61
  s_lshl_b32 s78, s94, 18
  s_lshl_b32 s79, s93, 7
  s_add_u32 s78, s78, s79
  s_add_u32 s78, s78, 0x200000
  s_cmp_lt_u32 s77, 56
  s_cselect_b32 s78, s78, s34
  s_cselect_b32 s79, 32768, 0
  s_waitcnt vmcnt(11)
  v_lshlrev_b32 v164, 16, v72
  v_lshlrev_b32 v165, 16, v74
  v_and_b32 v166, s59, v72
  v_and_b32 v167, s59, v74
  v_lshlrev_b32 v168, 16, v73
  v_lshlrev_b32 v169, 16, v75
  v_and_b32 v170, s59, v73
  v_and_b32 v171, s59, v75
  v_lshlrev_b32 v172, 16, v88
  v_and_b32 v173, s59, v88
  v_lshlrev_b32 v174, 16, v92
  v_and_b32 v175, s59, v92
  v_lshlrev_b32 v176, 16, v96
  v_and_b32 v177, s59, v96
  v_lshlrev_b32 v178, 16, v100
  v_and_b32 v179, s59, v100
  v_lshlrev_b32 v180, 16, v104
  v_and_b32 v181, s59, v104
  v_lshlrev_b32 v182, 16, v108
  v_and_b32 v183, s59, v108
  v_lshlrev_b32 v184, 16, v112
  v_and_b32 v185, s59, v112
  v_pk_mul_f32 v[186:187], v[178:179], v[164:165]
  v_pk_mul_f32 v[188:189], v[180:181], v[164:165]
  v_pk_mul_f32 v[190:191], v[182:183], v[164:165]
  v_pk_mul_f32 v[192:193], v[184:185], v[164:165]
  v_pk_fma_f32 v[186:187], v[176:177], v[166:167], v[186:187]
  v_pk_fma_f32 v[188:189], v[178:179], v[166:167], v[188:189]
  v_pk_fma_f32 v[190:191], v[180:181], v[166:167], v[190:191]
  v_pk_fma_f32 v[192:193], v[182:183], v[166:167], v[192:193]
  v_pk_fma_f32 v[186:187], v[174:175], v[168:169], v[186:187]
  v_pk_fma_f32 v[188:189], v[176:177], v[168:169], v[188:189]
  v_pk_fma_f32 v[190:191], v[178:179], v[168:169], v[190:191]
  v_pk_fma_f32 v[192:193], v[180:181], v[168:169], v[192:193]
  v_pk_fma_f32 v[186:187], v[172:173], v[170:171], v[186:187]
  v_pk_fma_f32 v[188:189], v[174:175], v[170:171], v[188:189]
  v_pk_fma_f32 v[190:191], v[176:177], v[170:171], v[190:191]
  v_pk_fma_f32 v[192:193], v[178:179], v[170:171], v[192:193]
  v_lshlrev_b32 v172, 16, v132
  v_and_b32 v173, s59, v132
  v_lshlrev_b32 v174, 16, v136
  v_and_b32 v175, s59, v136
  v_lshlrev_b32 v176, 16, v140
  v_and_b32 v177, s59, v140
  v_lshlrev_b32 v178, 16, v144
  v_and_b32 v179, s59, v144
  v_pk_mul_f32 v[186:187], v[186:187], v[172:173]
  v_pk_mul_f32 v[188:189], v[188:189], v[174:175]
  v_pk_mul_f32 v[190:191], v[190:191], v[176:177]
  v_pk_mul_f32 v[192:193], v[192:193], v[178:179]
  v_cvt_pk_bf16_f32 v208, v192, v190
  v_cvt_pk_bf16_f32 v209, v188, v186
  v_cvt_pk_bf16_f32 v212, v193, v191
  v_cvt_pk_bf16_f32 v213, v189, v187
  v_lshlrev_b32 v164, 16, v76
  v_lshlrev_b32 v165, 16, v78
  v_and_b32 v166, s59, v76
  v_and_b32 v167, s59, v78
  v_lshlrev_b32 v168, 16, v77
  v_lshlrev_b32 v169, 16, v79
  v_and_b32 v170, s59, v77
  v_and_b32 v171, s59, v79
  v_lshlrev_b32 v172, 16, v89
  v_and_b32 v173, s59, v89
  v_lshlrev_b32 v174, 16, v93
  v_and_b32 v175, s59, v93
  v_lshlrev_b32 v176, 16, v97
  v_and_b32 v177, s59, v97
  v_lshlrev_b32 v178, 16, v101
  v_and_b32 v179, s59, v101
  v_lshlrev_b32 v180, 16, v105
  v_and_b32 v181, s59, v105
  v_lshlrev_b32 v182, 16, v109
  v_and_b32 v183, s59, v109
  v_lshlrev_b32 v184, 16, v113
  v_and_b32 v185, s59, v113
  v_pk_mul_f32 v[186:187], v[178:179], v[164:165]
  v_pk_mul_f32 v[188:189], v[180:181], v[164:165]
  v_pk_mul_f32 v[190:191], v[182:183], v[164:165]
  v_pk_mul_f32 v[192:193], v[184:185], v[164:165]
  v_pk_fma_f32 v[186:187], v[176:177], v[166:167], v[186:187]
  v_pk_fma_f32 v[188:189], v[178:179], v[166:167], v[188:189]
  v_pk_fma_f32 v[190:191], v[180:181], v[166:167], v[190:191]
  v_pk_fma_f32 v[192:193], v[182:183], v[166:167], v[192:193]
  v_pk_fma_f32 v[186:187], v[174:175], v[168:169], v[186:187]
  v_pk_fma_f32 v[188:189], v[176:177], v[168:169], v[188:189]
  v_pk_fma_f32 v[190:191], v[178:179], v[168:169], v[190:191]
  v_pk_fma_f32 v[192:193], v[180:181], v[168:169], v[192:193]
  v_pk_fma_f32 v[186:187], v[172:173], v[170:171], v[186:187]
  v_pk_fma_f32 v[188:189], v[174:175], v[170:171], v[188:189]
  v_pk_fma_f32 v[190:191], v[176:177], v[170:171], v[190:191]
  v_pk_fma_f32 v[192:193], v[178:179], v[170:171], v[192:193]
  v_lshlrev_b32 v172, 16, v133
  v_and_b32 v173, s59, v133
  v_lshlrev_b32 v174, 16, v137
  v_and_b32 v175, s59, v137
  v_lshlrev_b32 v176, 16, v141
  v_and_b32 v177, s59, v141
  v_lshlrev_b32 v178, 16, v145
  v_and_b32 v179, s59, v145
  v_pk_mul_f32 v[186:187], v[186:187], v[172:173]
  v_pk_mul_f32 v[188:189], v[188:189], v[174:175]
  v_pk_mul_f32 v[190:191], v[190:191], v[176:177]
  v_pk_mul_f32 v[192:193], v[192:193], v[178:179]
  v_cvt_pk_bf16_f32 v216, v192, v190
  v_cvt_pk_bf16_f32 v217, v188, v186
  v_cvt_pk_bf16_f32 v220, v193, v191
  v_cvt_pk_bf16_f32 v221, v189, v187
  v_lshlrev_b32 v164, 16, v80
  v_lshlrev_b32 v165, 16, v82
  v_and_b32 v166, s59, v80
  v_and_b32 v167, s59, v82
  v_lshlrev_b32 v168, 16, v81
  v_lshlrev_b32 v169, 16, v83
  v_and_b32 v170, s59, v81
  v_and_b32 v171, s59, v83
  v_lshlrev_b32 v172, 16, v90
  v_and_b32 v173, s59, v90
  v_lshlrev_b32 v174, 16, v94
  v_and_b32 v175, s59, v94
  v_lshlrev_b32 v176, 16, v98
  v_and_b32 v177, s59, v98
  v_lshlrev_b32 v178, 16, v102
  v_and_b32 v179, s59, v102
  v_lshlrev_b32 v180, 16, v106
  v_and_b32 v181, s59, v106
  v_lshlrev_b32 v182, 16, v110
  v_and_b32 v183, s59, v110
  v_lshlrev_b32 v184, 16, v114
  v_and_b32 v185, s59, v114
  v_pk_mul_f32 v[186:187], v[178:179], v[164:165]
  v_pk_mul_f32 v[188:189], v[180:181], v[164:165]
  v_pk_mul_f32 v[190:191], v[182:183], v[164:165]
  v_pk_mul_f32 v[192:193], v[184:185], v[164:165]
  v_pk_fma_f32 v[186:187], v[176:177], v[166:167], v[186:187]
  v_pk_fma_f32 v[188:189], v[178:179], v[166:167], v[188:189]
  v_pk_fma_f32 v[190:191], v[180:181], v[166:167], v[190:191]
  v_pk_fma_f32 v[192:193], v[182:183], v[166:167], v[192:193]
  v_pk_fma_f32 v[186:187], v[174:175], v[168:169], v[186:187]
  v_pk_fma_f32 v[188:189], v[176:177], v[168:169], v[188:189]
  v_pk_fma_f32 v[190:191], v[178:179], v[168:169], v[190:191]
  v_pk_fma_f32 v[192:193], v[180:181], v[168:169], v[192:193]
  v_pk_fma_f32 v[186:187], v[172:173], v[170:171], v[186:187]
  v_pk_fma_f32 v[188:189], v[174:175], v[170:171], v[188:189]
  v_pk_fma_f32 v[190:191], v[176:177], v[170:171], v[190:191]
  v_pk_fma_f32 v[192:193], v[178:179], v[170:171], v[192:193]
  v_lshlrev_b32 v172, 16, v134
  v_and_b32 v173, s59, v134
  v_lshlrev_b32 v174, 16, v138
  v_and_b32 v175, s59, v138
  v_lshlrev_b32 v176, 16, v142
  v_and_b32 v177, s59, v142
  v_lshlrev_b32 v178, 16, v146
  v_and_b32 v179, s59, v146
  v_pk_mul_f32 v[186:187], v[186:187], v[172:173]
  v_pk_mul_f32 v[188:189], v[188:189], v[174:175]
  v_pk_mul_f32 v[190:191], v[190:191], v[176:177]
  v_pk_mul_f32 v[192:193], v[192:193], v[178:179]
  v_cvt_pk_bf16_f32 v224, v192, v190
  v_cvt_pk_bf16_f32 v225, v188, v186
  v_cvt_pk_bf16_f32 v228, v193, v191
  v_cvt_pk_bf16_f32 v229, v189, v187
  v_lshlrev_b32 v164, 16, v84
  v_lshlrev_b32 v165, 16, v86
  v_and_b32 v166, s59, v84
  v_and_b32 v167, s59, v86
  v_lshlrev_b32 v168, 16, v85
  v_lshlrev_b32 v169, 16, v87
  v_and_b32 v170, s59, v85
  v_and_b32 v171, s59, v87
  v_lshlrev_b32 v172, 16, v91
  v_and_b32 v173, s59, v91
  v_lshlrev_b32 v174, 16, v95
  v_and_b32 v175, s59, v95
  v_lshlrev_b32 v176, 16, v99
  v_and_b32 v177, s59, v99
  v_lshlrev_b32 v178, 16, v103
  v_and_b32 v179, s59, v103
  v_lshlrev_b32 v180, 16, v107
  v_and_b32 v181, s59, v107
  v_lshlrev_b32 v182, 16, v111
  v_and_b32 v183, s59, v111
  v_lshlrev_b32 v184, 16, v115
  v_and_b32 v185, s59, v115
  v_pk_mul_f32 v[186:187], v[178:179], v[164:165]
  v_pk_mul_f32 v[188:189], v[180:181], v[164:165]
  v_pk_mul_f32 v[190:191], v[182:183], v[164:165]
  v_pk_mul_f32 v[192:193], v[184:185], v[164:165]
  v_pk_fma_f32 v[186:187], v[176:177], v[166:167], v[186:187]
  v_pk_fma_f32 v[188:189], v[178:179], v[166:167], v[188:189]
  v_pk_fma_f32 v[190:191], v[180:181], v[166:167], v[190:191]
  v_pk_fma_f32 v[192:193], v[182:183], v[166:167], v[192:193]
  v_pk_fma_f32 v[186:187], v[174:175], v[168:169], v[186:187]
  v_pk_fma_f32 v[188:189], v[176:177], v[168:169], v[188:189]
  v_pk_fma_f32 v[190:191], v[178:179], v[168:169], v[190:191]
  v_pk_fma_f32 v[192:193], v[180:181], v[168:169], v[192:193]
  v_pk_fma_f32 v[186:187], v[172:173], v[170:171], v[186:187]
  v_pk_fma_f32 v[188:189], v[174:175], v[170:171], v[188:189]
  v_pk_fma_f32 v[190:191], v[176:177], v[170:171], v[190:191]
  v_pk_fma_f32 v[192:193], v[178:179], v[170:171], v[192:193]
  v_lshlrev_b32 v172, 16, v135
  v_and_b32 v173, s59, v135
  v_lshlrev_b32 v174, 16, v139
  v_and_b32 v175, s59, v139
  v_lshlrev_b32 v176, 16, v143
  v_and_b32 v177, s59, v143
  v_lshlrev_b32 v178, 16, v147
  v_and_b32 v179, s59, v147
  v_pk_mul_f32 v[186:187], v[186:187], v[172:173]
  v_pk_mul_f32 v[188:189], v[188:189], v[174:175]
  v_pk_mul_f32 v[190:191], v[190:191], v[176:177]
  v_pk_mul_f32 v[192:193], v[192:193], v[178:179]
  v_cvt_pk_bf16_f32 v232, v192, v190
  v_cvt_pk_bf16_f32 v233, v188, v186
  v_cvt_pk_bf16_f32 v236, v193, v191
  v_cvt_pk_bf16_f32 v237, v189, v187
  s_waitcnt vmcnt(3)
  v_lshlrev_b32 v164, 16, v72
  v_lshlrev_b32 v165, 16, v74
  v_and_b32 v166, s59, v72
  v_and_b32 v167, s59, v74
  v_lshlrev_b32 v168, 16, v73
  v_lshlrev_b32 v169, 16, v75
  v_and_b32 v170, s59, v73
  v_and_b32 v171, s59, v75
  v_lshlrev_b32 v172, 16, v104
  v_and_b32 v173, s59, v104
  v_lshlrev_b32 v174, 16, v108
  v_and_b32 v175, s59, v108
  v_lshlrev_b32 v176, 16, v112
  v_and_b32 v177, s59, v112
  v_lshlrev_b32 v178, 16, v116
  v_and_b32 v179, s59, v116
  v_lshlrev_b32 v180, 16, v120
  v_and_b32 v181, s59, v120
  v_lshlrev_b32 v182, 16, v124
  v_and_b32 v183, s59, v124
  v_lshlrev_b32 v184, 16, v128
  v_and_b32 v185, s59, v128
  v_pk_mul_f32 v[186:187], v[178:179], v[164:165]
  v_pk_mul_f32 v[188:189], v[180:181], v[164:165]
  v_pk_mul_f32 v[190:191], v[182:183], v[164:165]
  v_pk_mul_f32 v[192:193], v[184:185], v[164:165]
  v_pk_fma_f32 v[186:187], v[176:177], v[166:167], v[186:187]
  v_pk_fma_f32 v[188:189], v[178:179], v[166:167], v[188:189]
  v_pk_fma_f32 v[190:191], v[180:181], v[166:167], v[190:191]
  v_pk_fma_f32 v[192:193], v[182:183], v[166:167], v[192:193]
  v_pk_fma_f32 v[186:187], v[174:175], v[168:169], v[186:187]
  v_pk_fma_f32 v[188:189], v[176:177], v[168:169], v[188:189]
  v_pk_fma_f32 v[190:191], v[178:179], v[168:169], v[190:191]
  v_pk_fma_f32 v[192:193], v[180:181], v[168:169], v[192:193]
  v_pk_fma_f32 v[186:187], v[172:173], v[170:171], v[186:187]
  v_pk_fma_f32 v[188:189], v[174:175], v[170:171], v[188:189]
  v_pk_fma_f32 v[190:191], v[176:177], v[170:171], v[190:191]
  v_pk_fma_f32 v[192:193], v[178:179], v[170:171], v[192:193]
  v_lshlrev_b32 v172, 16, v148
  v_and_b32 v173, s59, v148
  v_lshlrev_b32 v174, 16, v152
  v_and_b32 v175, s59, v152
  v_lshlrev_b32 v176, 16, v156
  v_and_b32 v177, s59, v156
  v_lshlrev_b32 v178, 16, v160
  v_and_b32 v179, s59, v160
  v_pk_mul_f32 v[186:187], v[186:187], v[172:173]
  v_pk_mul_f32 v[188:189], v[188:189], v[174:175]
  v_pk_mul_f32 v[190:191], v[190:191], v[176:177]
  v_pk_mul_f32 v[192:193], v[192:193], v[178:179]
  v_cvt_pk_bf16_f32 v206, v192, v190
  v_cvt_pk_bf16_f32 v207, v188, v186
  ds_write_b128 v71, v[206:209] offset:0
  v_cvt_pk_bf16_f32 v210, v193, v191
  v_cvt_pk_bf16_f32 v211, v189, v187
  ds_write_b128 v71, v[210:213] offset:128
  v_lshlrev_b32 v164, 16, v76
  v_lshlrev_b32 v165, 16, v78
  v_and_b32 v166, s59, v76
  v_and_b32 v167, s59, v78
  v_lshlrev_b32 v168, 16, v77
  v_lshlrev_b32 v169, 16, v79
  v_and_b32 v170, s59, v77
  v_and_b32 v171, s59, v79
  v_lshlrev_b32 v172, 16, v105
  v_and_b32 v173, s59, v105
  v_lshlrev_b32 v174, 16, v109
  v_and_b32 v175, s59, v109
  v_lshlrev_b32 v176, 16, v113
  v_and_b32 v177, s59, v113
  v_lshlrev_b32 v178, 16, v117
  v_and_b32 v179, s59, v117
  v_lshlrev_b32 v180, 16, v121
  v_and_b32 v181, s59, v121
  v_lshlrev_b32 v182, 16, v125
  v_and_b32 v183, s59, v125
  v_lshlrev_b32 v184, 16, v129
  v_and_b32 v185, s59, v129
  v_pk_mul_f32 v[186:187], v[178:179], v[164:165]
  v_pk_mul_f32 v[188:189], v[180:181], v[164:165]
  v_pk_mul_f32 v[190:191], v[182:183], v[164:165]
  v_pk_mul_f32 v[192:193], v[184:185], v[164:165]
  v_pk_fma_f32 v[186:187], v[176:177], v[166:167], v[186:187]
  v_pk_fma_f32 v[188:189], v[178:179], v[166:167], v[188:189]
  v_pk_fma_f32 v[190:191], v[180:181], v[166:167], v[190:191]
  v_pk_fma_f32 v[192:193], v[182:183], v[166:167], v[192:193]
  v_pk_fma_f32 v[186:187], v[174:175], v[168:169], v[186:187]
  v_pk_fma_f32 v[188:189], v[176:177], v[168:169], v[188:189]
  v_pk_fma_f32 v[190:191], v[178:179], v[168:169], v[190:191]
  v_pk_fma_f32 v[192:193], v[180:181], v[168:169], v[192:193]
  v_pk_fma_f32 v[186:187], v[172:173], v[170:171], v[186:187]
  v_pk_fma_f32 v[188:189], v[174:175], v[170:171], v[188:189]
  v_pk_fma_f32 v[190:191], v[176:177], v[170:171], v[190:191]
  v_pk_fma_f32 v[192:193], v[178:179], v[170:171], v[192:193]
  v_lshlrev_b32 v172, 16, v149
  v_and_b32 v173, s59, v149
  v_lshlrev_b32 v174, 16, v153
  v_and_b32 v175, s59, v153
  v_lshlrev_b32 v176, 16, v157
  v_and_b32 v177, s59, v157
  v_lshlrev_b32 v178, 16, v161
  v_and_b32 v179, s59, v161
  v_pk_mul_f32 v[186:187], v[186:187], v[172:173]
  v_pk_mul_f32 v[188:189], v[188:189], v[174:175]
  v_pk_mul_f32 v[190:191], v[190:191], v[176:177]
  v_pk_mul_f32 v[192:193], v[192:193], v[178:179]
  v_cvt_pk_bf16_f32 v214, v192, v190
  v_cvt_pk_bf16_f32 v215, v188, v186
  ds_write_b128 v71, v[214:217] offset:256
  v_cvt_pk_bf16_f32 v218, v193, v191
  v_cvt_pk_bf16_f32 v219, v189, v187
  ds_write_b128 v71, v[218:221] offset:384
  v_lshlrev_b32 v164, 16, v80
  v_lshlrev_b32 v165, 16, v82
  v_and_b32 v166, s59, v80
  v_and_b32 v167, s59, v82
  v_lshlrev_b32 v168, 16, v81
  v_lshlrev_b32 v169, 16, v83
  v_and_b32 v170, s59, v81
  v_and_b32 v171, s59, v83
  v_lshlrev_b32 v172, 16, v106
  v_and_b32 v173, s59, v106
  v_lshlrev_b32 v174, 16, v110
  v_and_b32 v175, s59, v110
  v_lshlrev_b32 v176, 16, v114
  v_and_b32 v177, s59, v114
  v_lshlrev_b32 v178, 16, v118
  v_and_b32 v179, s59, v118
  v_lshlrev_b32 v180, 16, v122
  v_and_b32 v181, s59, v122
  v_lshlrev_b32 v182, 16, v126
  v_and_b32 v183, s59, v126
  v_lshlrev_b32 v184, 16, v130
  v_and_b32 v185, s59, v130
  v_pk_mul_f32 v[186:187], v[178:179], v[164:165]
  v_pk_mul_f32 v[188:189], v[180:181], v[164:165]
  v_pk_mul_f32 v[190:191], v[182:183], v[164:165]
  v_pk_mul_f32 v[192:193], v[184:185], v[164:165]
  v_pk_fma_f32 v[186:187], v[176:177], v[166:167], v[186:187]
  v_pk_fma_f32 v[188:189], v[178:179], v[166:167], v[188:189]
  v_pk_fma_f32 v[190:191], v[180:181], v[166:167], v[190:191]
  v_pk_fma_f32 v[192:193], v[182:183], v[166:167], v[192:193]
  v_pk_fma_f32 v[186:187], v[174:175], v[168:169], v[186:187]
  v_pk_fma_f32 v[188:189], v[176:177], v[168:169], v[188:189]
  v_pk_fma_f32 v[190:191], v[178:179], v[168:169], v[190:191]
  v_pk_fma_f32 v[192:193], v[180:181], v[168:169], v[192:193]
  v_pk_fma_f32 v[186:187], v[172:173], v[170:171], v[186:187]
  v_pk_fma_f32 v[188:189], v[174:175], v[170:171], v[188:189]
  v_pk_fma_f32 v[190:191], v[176:177], v[170:171], v[190:191]
  v_pk_fma_f32 v[192:193], v[178:179], v[170:171], v[192:193]
  v_lshlrev_b32 v172, 16, v150
  v_and_b32 v173, s59, v150
  v_lshlrev_b32 v174, 16, v154
  v_and_b32 v175, s59, v154
  v_lshlrev_b32 v176, 16, v158
  v_and_b32 v177, s59, v158
  v_lshlrev_b32 v178, 16, v162
  v_and_b32 v179, s59, v162
  v_pk_mul_f32 v[186:187], v[186:187], v[172:173]
  v_pk_mul_f32 v[188:189], v[188:189], v[174:175]
  v_pk_mul_f32 v[190:191], v[190:191], v[176:177]
  v_pk_mul_f32 v[192:193], v[192:193], v[178:179]
  v_cvt_pk_bf16_f32 v222, v192, v190
  v_cvt_pk_bf16_f32 v223, v188, v186
  ds_write_b128 v71, v[222:225] offset:512
  v_cvt_pk_bf16_f32 v226, v193, v191
  v_cvt_pk_bf16_f32 v227, v189, v187
  ds_write_b128 v71, v[226:229] offset:640
  v_lshlrev_b32 v164, 16, v84
  v_lshlrev_b32 v165, 16, v86
  v_and_b32 v166, s59, v84
  v_and_b32 v167, s59, v86
  v_lshlrev_b32 v168, 16, v85
  v_lshlrev_b32 v169, 16, v87
  v_and_b32 v170, s59, v85
  v_and_b32 v171, s59, v87
  v_lshlrev_b32 v172, 16, v107
  v_and_b32 v173, s59, v107
  v_lshlrev_b32 v174, 16, v111
  v_and_b32 v175, s59, v111
  v_lshlrev_b32 v176, 16, v115
  v_and_b32 v177, s59, v115
  v_lshlrev_b32 v178, 16, v119
  v_and_b32 v179, s59, v119
  v_lshlrev_b32 v180, 16, v123
  v_and_b32 v181, s59, v123
  v_lshlrev_b32 v182, 16, v127
  v_and_b32 v183, s59, v127
  v_lshlrev_b32 v184, 16, v131
  v_and_b32 v185, s59, v131
  v_pk_mul_f32 v[186:187], v[178:179], v[164:165]
  v_pk_mul_f32 v[188:189], v[180:181], v[164:165]
  v_pk_mul_f32 v[190:191], v[182:183], v[164:165]
  v_pk_mul_f32 v[192:193], v[184:185], v[164:165]
  v_pk_fma_f32 v[186:187], v[176:177], v[166:167], v[186:187]
  v_pk_fma_f32 v[188:189], v[178:179], v[166:167], v[188:189]
  v_pk_fma_f32 v[190:191], v[180:181], v[166:167], v[190:191]
  v_pk_fma_f32 v[192:193], v[182:183], v[166:167], v[192:193]
  v_pk_fma_f32 v[186:187], v[174:175], v[168:169], v[186:187]
  v_pk_fma_f32 v[188:189], v[176:177], v[168:169], v[188:189]
  v_pk_fma_f32 v[190:191], v[178:179], v[168:169], v[190:191]
  v_pk_fma_f32 v[192:193], v[180:181], v[168:169], v[192:193]
  v_pk_fma_f32 v[186:187], v[172:173], v[170:171], v[186:187]
  v_pk_fma_f32 v[188:189], v[174:175], v[170:171], v[188:189]
  v_pk_fma_f32 v[190:191], v[176:177], v[170:171], v[190:191]
  v_pk_fma_f32 v[192:193], v[178:179], v[170:171], v[192:193]
  v_lshlrev_b32 v172, 16, v151
  v_and_b32 v173, s59, v151
  v_lshlrev_b32 v174, 16, v155
  v_and_b32 v175, s59, v155
  v_lshlrev_b32 v176, 16, v159
  v_and_b32 v177, s59, v159
  v_lshlrev_b32 v178, 16, v163
  v_and_b32 v179, s59, v163
  v_pk_mul_f32 v[186:187], v[186:187], v[172:173]
  v_pk_mul_f32 v[188:189], v[188:189], v[174:175]
  v_pk_mul_f32 v[190:191], v[190:191], v[176:177]
  v_pk_mul_f32 v[192:193], v[192:193], v[178:179]
  v_cvt_pk_bf16_f32 v230, v192, v190
  v_cvt_pk_bf16_f32 v231, v188, v186
  ds_write_b128 v71, v[230:233] offset:768
  v_cvt_pk_bf16_f32 v234, v193, v191
  v_cvt_pk_bf16_f32 v235, v189, v187
  ds_write_b128 v71, v[234:237] offset:896
  ds_read_b128 v[88:91], v60 offset:0
  ds_read_b128 v[92:95], v60 offset:1024
  ds_read_b128 v[96:99], v60 offset:2048
  ds_read_b128 v[100:103], v60 offset:3072
  ds_read_b128 v[104:107], v60 offset:4096
  ds_read_b128 v[108:111], v60 offset:5120
  ds_read_b128 v[112:115], v60 offset:6144
  ds_read_b128 v[116:119], v60 offset:7168
  v_xor_b32 v50, 0, v61
  v_xor_b32 v51, 16, v61
  v_xor_b32 v52, 32, v61
  v_xor_b32 v53, 48, v61
  v_xor_b32 v54, 64, v61
  v_xor_b32 v55, 80, v61
  v_xor_b32 v56, 96, v61
  v_xor_b32 v57, 112, v61
  s_waitcnt lgkmcnt(7)
  buffer_store_dwordx4 v[88:91], v50, s[32:35], s78 offen sc1
  s_add_u32 s78, s78, s79
  s_waitcnt lgkmcnt(6)
  buffer_store_dwordx4 v[92:95], v51, s[32:35], s78 offen sc1
  s_add_u32 s78, s78, s79
  s_waitcnt lgkmcnt(5)
  buffer_store_dwordx4 v[96:99], v52, s[32:35], s78 offen sc1
  s_add_u32 s78, s78, s79
  s_waitcnt lgkmcnt(4)
  buffer_store_dwordx4 v[100:103], v53, s[32:35], s78 offen sc1
  s_add_u32 s78, s78, s79
  s_waitcnt lgkmcnt(3)
  buffer_store_dwordx4 v[104:107], v54, s[32:35], s78 offen sc1
  s_add_u32 s78, s78, s79
  s_waitcnt lgkmcnt(2)
  buffer_store_dwordx4 v[108:111], v55, s[32:35], s78 offen sc1
  s_add_u32 s78, s78, s79
  s_waitcnt lgkmcnt(1)
  buffer_store_dwordx4 v[112:115], v56, s[32:35], s78 offen sc1
  s_add_u32 s78, s78, s79
  s_waitcnt lgkmcnt(0)
  buffer_store_dwordx4 v[116:119], v57, s[32:35], s78 offen sc1
  s_add_u32 s78, s78, s79
  s_lshl_b32 s96, s77, 7
  s_add_u32 s96, s96, 0xa08000
  s_waitcnt vmcnt(0)
  s_barrier
  s_cmp_lg_u32 s56, 0
  s_cbranch_scc1 L_FK6
  v_mov_b32 v249, s96
  s_mov_b64 exec, 1
  buffer_store_dword v255, v249, s[32:35], 0 offen sc1
  s_mov_b64 exec, -1
L_FK6:
  s_cmp_ge_u32 s58, 28
  s_cbranch_scc1 L_NOLATE
  s_mov_b32 s44, s12
  s_mov_b32 s45, s13
  s_mov_b32 s46, 0x1c0000
  s_mov_b32 s47, 0x20000
  buffer_load_dwordx2 v[206:207], v202, s[44:47], s91 offen
  buffer_load_dwordx4 v[208:211], v200, s[44:47], s91 offen
  buffer_load_dwordx2 v[212:213], v201, s[44:47], s91 offen
  buffer_load_dwordx4 v[214:217], v200, s[44:47], s91 offen offset:1024
  v_readfirstlane_b32 s89, v205
  s_nop 1
  v_mov_b32 v205, s89
L_NOLATE:
  v_mov_b32 v69, 0x80000000
  s_cmp_lt_u32 s75, 28
  s_cbranch_scc0 L_NOHP
  buffer_load_dword v253, v29, s[48:51], s72 offen
  s_add_u32 s72, s72, 458752
L_NOHP:
  s_cmp_ge_u32 s58, 28
  s_cbranch_scc1 L_HELP
  s_waitcnt vmcnt(0)
  s_lshr_b32 s62, s56, 1
  s_mul_i32 s92, s62, 21248
  s_add_u32 s92, s92, 114688
  v_add_u32 v219, s92, v200
  ds_write_b128 v219, v[208:211] offset:64
  v_alignbit_b32 v220, v208, v207, 16
  v_alignbit_b32 v221, v209, v208, 16
  v_alignbit_b32 v222, v210, v209, 16
  v_alignbit_b32 v223, v211, v210, 16
  ds_write_b128 v219, v[220:223] offset:4224
  v_mov_b32 v224, v207
  v_mov_b32 v225, v208
  v_mov_b32 v226, v209
  v_mov_b32 v227, v210
  ds_write_b128 v219, v[224:227] offset:8384
  v_alignbit_b32 v228, v207, v206, 16
  v_alignbit_b32 v229, v208, v207, 16
  v_alignbit_b32 v230, v209, v208, 16
  v_alignbit_b32 v231, v210, v209, 16
  ds_write_b128 v219, v[228:231] offset:12544
  ds_write_b128 v219, v[214:217] offset:1088
  v_alignbit_b32 v220, v214, v213, 16
  v_alignbit_b32 v221, v215, v214, 16
  v_alignbit_b32 v222, v216, v215, 16
  v_alignbit_b32 v223, v217, v216, 16
  ds_write_b128 v219, v[220:223] offset:5248
  v_mov_b32 v224, v213
  v_mov_b32 v225, v214
  v_mov_b32 v226, v215
  v_mov_b32 v227, v216
  ds_write_b128 v219, v[224:227] offset:9408
  v_alignbit_b32 v228, v213, v212, 16
  v_alignbit_b32 v229, v214, v213, 16
  v_alignbit_b32 v230, v215, v214, 16
  v_alignbit_b32 v231, v216, v215, 16
  ds_write_b128 v219, v[228:231] offset:13568
  v_mov_b64 v[232:233], 0
  v_mov_b64 v[234:235], 0
  v_lshrrev_b32 v236, 2, v1
  v_min_u32 v236, 4, v236
  v_mul_u32_u24 v236, 4160, v236
  v_lshlrev_b32 v237, 4, v1
  v_subrev_u32 v238, 256, v237
  v_and_b32 v237, 48, v237
  v_cmp_gt_u32 vcc, 16, v1
  v_and_b32 v239, 15, v1
  v_lshrrev_b32 v240, 4, v1
  v_cndmask_b32 v237, v238, v237, vcc
  v_add3_u32 v236, v236, v237, s92
  s_mov_b32 exec_hi, 0xffff
  ds_write_b128 v236, v[232:235]
  s_mov_b32 exec_hi, -1
  s_and_b32 s62, s56, 1
  s_lshl_b32 s63, s62, 8
  v_sub_u32 v241, 3, v239
  v_and_b32 v241, 3, v241
  v_add3_u32 v192, v239, v241, 9
  v_lshlrev_b32 v242, 3, v240
  v_sub_u32 v192, v192, v242
  v_mul_u32_u24 v241, 4160, v241
  v_lshl_add_u32 v192, v192, 1, v241
  s_add_u32 s96, s92, s63
  v_add3_u32 v192, v192, s96, 64
  v_lshlrev_b32 v193, 5, v239
  v_lshl_add_u32 v193, v240, 4, v193
  s_sub_u32 s96, s92, s63
  s_add_u32 s96, s96, 17120
  v_add_u32 v193, s96, v193
  v_lshlrev_b32 v194, 5, v239
  v_and_b32 v242, 1, v240
  v_lshl_add_u32 v194, v242, 9, v194
  v_lshrrev_b32 v242, 1, v240
  v_lshl_add_u32 v194, v242, 4, v194
  s_lshl_b32 s63, s62, 11
  s_add_u32 s69, s69, s63
  s_add_u32 s69, s69, 0x800000
  v_lshrrev_b32 v242, 3, v239
  s_lshl_b32 s62, s62, 3
  v_add3_u32 v242, v242, s62, 2
  v_cmp_eq_u32 vcc, v242, v240
  v_and_b32 v243, 1, v239
  v_lshlrev_b32 v244, 16, v205
  v_cndmask_b32 v205, 0, v205, vcc
  v_cndmask_b32 v244, 0, v244, vcc
  v_cmp_eq_u32 vcc, 0, v243
  v_bfe_u32 v245, v239, 1, 2
  s_nop 0
  v_cndmask_b32 v205, v205, v244, vcc
  v_cmp_eq_u32 vcc, 3, v245
  s_nop 1
  v_cndmask_b32 v196, 0, v205, vcc
  v_cmp_eq_u32 vcc, 2, v245
  s_nop 1
  v_cndmask_b32 v197, 0, v205, vcc
  v_cmp_eq_u32 vcc, 1, v245
  s_nop 1
  v_cndmask_b32 v198, 0, v205, vcc
  v_cmp_eq_u32 vcc, 0, v245
  s_nop 1
  v_cndmask_b32 v199, 0, v205, vcc
  buffer_load_dword v250, v23, s[32:35], 0 offen sc1
  buffer_load_dword v251, v24, s[32:35], 0 offen sc1
  s_waitcnt vmcnt(0)
  s_mov_b32 s60, 0
  s_branch L_P7_C
L_P7_L:
  s_sleep 2
  buffer_load_dword v250, v23, s[32:35], 0 offen sc1
  s_waitcnt vmcnt(0)
L_P7_C:
  v_cmp_ne_u32 vcc, v255, v250
  s_and_b64 exec, exec, vcc
  s_cbranch_scc0 L_P7_OK
  s_add_u32 s60, s60, 1
  s_cmp_lt_u32 s60, 0x8000
  s_cbranch_scc1 L_P7_L
L_P7_OK:
  s_mov_b64 exec, -1
  s_mov_b32 s60, 0
  s_branch L_P8_C
L_P8_L:
  s_sleep 2
  buffer_load_dword v251, v24, s[32:35], 0 offen sc1
  s_waitcnt vmcnt(0)
L_P8_C:
  v_cmp_ne_u32 vcc, v255, v251
  s_and_b64 exec, exec, vcc
  s_cbranch_scc0 L_P8_OK
  s_add_u32 s60, s60, 1
  s_cmp_lt_u32 s60, 0x8000
  s_cbranch_scc1 L_P8_L
L_P8_OK:
  s_mov_b64 exec, -1
  s_barrier
  s_and_b32 s62, s56, 1
  s_lshl_b32 s62, s62, 11
  s_add_u32 s62, s62, s92
  s_add_u32 m0, s62, 17152
  s_sub_u32 s63, s69, 0x600000
  v_lshlrev_b32 v4, 4, v1
  buffer_load_dwordx4 v4, s[32:35], s63 offen sc1 lds
  buffer_load_dwordx4 v4, s[32:35], s63 offen offset:1024 sc1 lds
  s_mov_b32 s36, s4
  s_mov_b32 s37, s5
  s_mov_b32 s38, 0x1c0000
  s_mov_b32 s39, 0x20000
  buffer_load_dwordx4 v[40:43], v195, s[36:39], s88 offen offset:0
  buffer_load_dwordx4 v[44:47], v195, s[36:39], s88 offen offset:32
  s_mov_b32 s40, s24
  s_mov_b32 s41, s25
  s_mov_b32 s42, 0x1000
  s_mov_b32 s43, 0x20000
  buffer_load_ushort v48, v22, s[40:43], 0 offen
  s_add_u32 m0, s61, 0
  s_nop 0
  buffer_load_dwordx4 v8, s[48:51], s67 offen lds
  buffer_load_dwordx4 v9, s[48:51], s67 offen offset:1024 lds
  s_add_u32 m0, s61, 2048
  s_add_u32 s67, s67, 65536
  buffer_load_dwordx4 v8, s[48:51], s67 offen lds
  buffer_load_dwordx4 v9, s[48:51], s67 offen offset:1024 lds
  s_add_u32 m0, s61, 4096
  s_add_u32 s67, s67, 65536
  buffer_load_dwordx4 v8, s[48:51], s67 offen lds
  buffer_load_dwordx4 v9, s[48:51], s67 offen offset:1024 lds
  s_add_u32 m0, s61, 6144
  s_add_u32 s67, s67, 65536
  buffer_load_dwordx4 v8, s[48:51], s67 offen lds
  buffer_load_dwordx4 v9, s[48:51], s67 offen offset:1024 lds
  s_waitcnt vmcnt(11)
  s_waitcnt lgkmcnt(0)
  s_barrier
  buffer_load_dwordx2 v[50:51], v49, s[32:35], 0 offen sc1
  buffer_load_dword v253, v69, s[32:35], 0 offen
  buffer_load_dword v253, v69, s[32:35], 0 offen
  s_lshl_b32 s96, s2, 2
  s_add_u32 s96, s96, s56
  s_lshl_b32 s96, s96, 7
  s_add_u32 s96, s96, 0xa60080
L_MID:
  s_add_u32 m0, s61, 8192
  s_add_u32 s67, s67, 65536
  buffer_load_dwordx4 v8, s[48:51], s67 offen lds
  buffer_load_dwordx4 v9, s[48:51], s67 offen offset:1024 lds
  s_add_u32 m0, s61, 10240
  s_add_u32 s67, s67, 65536
  buffer_load_dwordx4 v8, s[48:51], s67 offen lds
  buffer_load_dwordx4 v9, s[48:51], s67 offen offset:1024 lds
  s_mul_i32 s62, s56, 49
  s_add_u32 s62, s62, s87
  v_lshrrev_b32 v23, 2, v1
  v_min_u32 v23, 6, v23
  v_mul_u32_u24 v23, 7, v23
  v_add_u32 v23, s62, v23
  v_and_b32 v24, 0, v1
  v_lshl_add_u32 v23, v23, 2, v24
  v_lshlrev_b32 v23, 7, v23
  v_add_u32 v23, 0xa10000, v23
  ds_read_b128 v[160:163], v193 offset:0
  ds_read_b128 v[164:167], v193 offset:512
  ds_read_b128 v[168:171], v193 offset:1024
  ds_read_b128 v[172:175], v193 offset:1536
  ds_read_b128 v[176:179], v193 offset:2048
  ds_read_b128 v[180:183], v193 offset:2560
  ds_read_b128 v[184:187], v193 offset:3072
  ds_read_b128 v[188:191], v193 offset:3584
  ds_read_b64 v[124:125], v192 offset:3584
  ds_read_b64 v[126:127], v192 offset:3592
  ds_read_b64 v[120:121], v192 offset:3072
  ds_read_b64 v[122:123], v192 offset:3080
  ds_read_b64 v[116:117], v192 offset:2560
  ds_read_b64 v[118:119], v192 offset:2568
  s_waitcnt lgkmcnt(13)
  v_mfma_f32_16x16x32_bf16 v[200:203], v[196:199], v[160:163], 0
  ds_read_b64 v[112:113], v192 offset:2048
  ds_read_b64 v[114:115], v192 offset:2056
  s_waitcnt lgkmcnt(14)
  v_mfma_f32_16x16x32_bf16 v[204:207], v[196:199], v[164:167], 0
  s_waitcnt vmcnt(13)
  ds_read_b64_tr_b16 a[0:1], v13 offset:0
  ds_read_b64_tr_b16 a[2:3], v13 offset:512
  ds_read_b64 v[108:109], v192 offset:1536
  ds_read_b64 v[110:111], v192 offset:1544
  s_waitcnt lgkmcnt(14)
  v_mfma_f32_16x16x32_bf16 v[208:211], v[196:199], v[168:171], 0
  ds_read_b64 v[104:105], v192 offset:1024
  ds_read_b64 v[106:107], v192 offset:1032
  s_waitcnt lgkmcnt(14)
  v_mfma_f32_16x16x32_bf16 v[212:215], v[196:199], v[172:175], 0
  ds_read_b64_tr_b16 a[4:5], v14 offset:0
  ds_read_b64_tr_b16 a[6:7], v14 offset:512
  ds_read_b64 v[100:101], v192 offset:512
  ds_read_b64 v[102:103], v192 offset:520
  s_waitcnt lgkmcnt(14)
  v_mfma_f32_16x16x32_bf16 v[216:219], v[196:199], v[176:179], 0
  ds_read_b64 v[96:97], v192 offset:0
  ds_read_b64 v[98:99], v192 offset:8
  s_waitcnt lgkmcnt(14)
  v_mfma_f32_16x16x32_bf16 v[220:223], v[196:199], v[180:183], 0
  s_waitcnt vmcnt(11)
  ds_read_b64_tr_b16 a[8:9], v13 offset:2048
  ds_read_b64_tr_b16 a[10:11], v13 offset:2560
  s_waitcnt lgkmcnt(14)
  v_mfma_f32_16x16x32_bf16 v[224:227], v[196:199], v[184:187], 0
  ds_read_b64_tr_b16 a[12:13], v14 offset:2048
  ds_read_b64_tr_b16 a[14:15], v14 offset:2560
  s_waitcnt lgkmcnt(14)
  v_mfma_f32_16x16x32_bf16 v[228:231], v[196:199], v[188:191], 0
  v_add_u32 v192, 64, v192
  v_subrev_u32 v193, 64, v193
  s_waitcnt lgkmcnt(14)
  v_mfma_f32_16x16x32_bf16 v[228:231], v[124:127], v[160:163], v[228:231]
  s_waitcnt lgkmcnt(8)
  s_add_u32 m0, s61, 0
  s_add_u32 s67, s67, 65536
  buffer_load_dwordx4 v8, s[48:51], s67 offen lds
  ds_read_b64 v[124:125], v192 offset:3584
  ds_read_b64 v[126:127], v192 offset:3592
  v_mfma_f32_16x16x32_bf16 v[224:227], v[120:123], v[160:163], v[224:227]
  v_mfma_f32_16x16x32_bf16 v[228:231], v[120:123], v[164:167], v[228:231]
  buffer_load_dwordx4 v9, s[48:51], s67 offen offset:1024 lds
  ds_read_b64 v[120:121], v192 offset:3072
  ds_read_b64 v[122:123], v192 offset:3080
  v_mfma_f32_16x16x32_bf16 v[220:223], v[116:119], v[160:163], v[220:223]
  s_waitcnt vmcnt(11)
  ds_read_b64_tr_b16 a[16:17], v13 offset:4096
  ds_read_b64_tr_b16 a[18:19], v13 offset:4608
  v_mfma_f32_16x16x32_bf16 v[224:227], v[116:119], v[164:167], v[224:227]
  v_mfma_f32_16x16x32_bf16 v[228:231], v[116:119], v[168:171], v[228:231]
  ds_read_b64_tr_b16 a[20:21], v14 offset:4096
  ds_read_b64_tr_b16 a[22:23], v14 offset:4608
  ds_read_b64 v[116:117], v192 offset:2560
  ds_read_b64 v[118:119], v192 offset:2568
  v_mfma_f32_16x16x32_bf16 v[216:219], v[112:115], v[160:163], v[216:219]
  v_mfma_f32_16x16x32_bf16 v[220:223], v[112:115], v[164:167], v[220:223]
  s_waitcnt lgkmcnt(10)
  s_add_u32 m0, s61, 2048
  s_add_u32 s67, s67, 65536
  buffer_load_dwordx4 v8, s[48:51], s67 offen lds
  v_mfma_f32_16x16x32_bf16 v[224:227], v[112:115], v[168:171], v[224:227]
  buffer_load_dwordx4 v9, s[48:51], s67 offen offset:1024 lds
  v_mfma_f32_16x16x32_bf16 v[228:231], v[112:115], v[172:175], v[228:231]
  ds_read_b64 v[112:113], v192 offset:2048
  ds_read_b64 v[114:115], v192 offset:2056
  v_mfma_f32_16x16x32_bf16 v[212:215], v[108:111], v[160:163], v[212:215]
  s_waitcnt vmcnt(11)
  ds_read_b64_tr_b16 a[24:25], v13 offset:6144
  ds_read_b64_tr_b16 a[26:27], v13 offset:6656
  v_mfma_f32_16x16x32_bf16 v[216:219], v[108:111], v[164:167], v[216:219]
  v_mfma_f32_16x16x32_bf16 v[220:223], v[108:111], v[168:171], v[220:223]
  ds_read_b64_tr_b16 a[28:29], v14 offset:6144
  ds_read_b64_tr_b16 a[30:31], v14 offset:6656
  v_mfma_f32_16x16x32_bf16 v[224:227], v[108:111], v[172:175], v[224:227]
  v_mfma_f32_16x16x32_bf16 v[228:231], v[108:111], v[176:179], v[228:231]
  s_waitcnt lgkmcnt(8)
  s_add_u32 m0, s61, 4096
  s_add_u32 s67, s67, 65536
  buffer_load_dwordx4 v8, s[48:51], s67 offen lds
  ds_read_b64 v[108:109], v192 offset:1536
  ds_read_b64 v[110:111], v192 offset:1544
  v_mfma_f32_16x16x32_bf16 v[208:211], v[104:107], v[160:163], v[208:211]
  buffer_load_dwordx4 v9, s[48:51], s67 offen offset:1024 lds
  v_mfma_f32_16x16x32_bf16 v[212:215], v[104:107], v[164:167], v[212:215]
  v_mfma_f32_16x16x32_bf16 v[216:219], v[104:107], v[168:171], v[216:219]
  s_waitcnt vmcnt(8)
  ds_read_b64_tr_b16 a[32:33], v13 offset:8192
  ds_read_b64_tr_b16 a[34:35], v13 offset:8704
  v_mfma_f32_16x16x32_bf16 v[220:223], v[104:107], v[172:175], v[220:223]
  v_mfma_f32_16x16x32_bf16 v[224:227], v[104:107], v[176:179], v[224:227]
  ds_read_b64_tr_b16 a[36:37], v14 offset:8192
  ds_read_b64_tr_b16 a[38:39], v14 offset:8704
  v_mfma_f32_16x16x32_bf16 v[228:231], v[104:107], v[180:183], v[228:231]
  s_waitcnt lgkmcnt(6)
  s_add_u32 m0, s61, 6144
  s_add_u32 s67, s67, 65536
  buffer_load_dwordx4 v8, s[48:51], s67 offen lds
  ds_read_b64 v[104:105], v192 offset:1024
  ds_read_b64 v[106:107], v192 offset:1032
  s_barrier
  s_cmp_lg_u32 s56, 0
  s_cbranch_scc1 L_UF9
  v_mov_b32 v249, s96
  s_mov_b64 exec, 1
  buffer_store_dword v255, v249, s[32:35], 0 offen sc1
  s_mov_b64 exec, -1
L_UF9:
  v_mfma_f32_16x16x32_bf16 v[204:207], v[100:103], v[160:163], v[204:207]
  v_mfma_f32_16x16x32_bf16 v[208:211], v[100:103], v[164:167], v[208:211]
  buffer_load_dwordx4 v9, s[48:51], s67 offen offset:1024 lds
  v_mfma_f32_16x16x32_bf16 v[212:215], v[100:103], v[168:171], v[212:215]
  v_mfma_f32_16x16x32_bf16 v[216:219], v[100:103], v[172:175], v[216:219]
  s_waitcnt vmcnt(8)
  ds_read_b64_tr_b16 a[40:41], v13 offset:10240
  ds_read_b64_tr_b16 a[42:43], v13 offset:10752
  v_mfma_f32_16x16x32_bf16 v[220:223], v[100:103], v[176:179], v[220:223]
  ds_read_b64_tr_b16 a[44:45], v14 offset:10240
  ds_read_b64_tr_b16 a[46:47], v14 offset:10752
  v_mfma_f32_16x16x32_bf16 v[224:227], v[100:103], v[180:183], v[224:227]
  v_mfma_f32_16x16x32_bf16 v[228:231], v[100:103], v[184:187], v[228:231]
  s_waitcnt lgkmcnt(6)
  s_add_u32 m0, s61, 8192
  s_add_u32 s67, s67, 65536
  buffer_load_dwordx4 v8, s[48:51], s67 offen lds
  ds_read_b64 v[100:101], v192 offset:512
  ds_read_b64 v[102:103], v192 offset:520
  v_mfma_f32_16x16x32_bf16 v[200:203], v[96:99], v[160:163], v[200:203]
  ds_read_b128 v[160:163], v193 offset:0
  v_mfma_f32_16x16x32_bf16 v[204:207], v[96:99], v[164:167], v[204:207]
  buffer_load_dwordx4 v9, s[48:51], s67 offen offset:1024 lds
  ds_read_b128 v[164:167], v193 offset:512
  v_mfma_f32_16x16x32_bf16 v[208:211], v[96:99], v[168:171], v[208:211]
  ds_read_b128 v[168:171], v193 offset:1024
  v_mfma_f32_16x16x32_bf16 v[212:215], v[96:99], v[172:175], v[212:215]
  s_waitcnt vmcnt(8)
  ds_read_b64_tr_b16 a[48:49], v13 offset:0
  ds_read_b64_tr_b16 a[50:51], v13 offset:512
  ds_read_b128 v[172:175], v193 offset:1536
  v_mfma_f32_16x16x32_bf16 v[216:219], v[96:99], v[176:179], v[216:219]
  ds_read_b64_tr_b16 a[52:53], v14 offset:0
  ds_read_b64_tr_b16 a[54:55], v14 offset:512
  ds_read_b128 v[176:179], v193 offset:2048
  v_mfma_f32_16x16x32_bf16 v[220:223], v[96:99], v[180:183], v[220:223]
  ds_read_b128 v[180:183], v193 offset:2560
  v_mfma_f32_16x16x32_bf16 v[224:227], v[96:99], v[184:187], v[224:227]
  s_waitcnt lgkmcnt(12)
  s_add_u32 m0, s61, 10240
  s_add_u32 s67, s67, 65536
  buffer_load_dwordx4 v8, s[48:51], s67 offen lds
  ds_read_b128 v[184:187], v193 offset:3072
  v_mfma_f32_16x16x32_bf16 v[228:231], v[96:99], v[188:191], v[228:231]
  ds_read_b128 v[188:191], v193 offset:3584
  ds_read_b64 v[96:97], v192 offset:0
  ds_read_b64 v[98:99], v192 offset:8
  v_add_u32 v192, 64, v192
  v_subrev_u32 v193, 64, v193
  s_waitcnt lgkmcnt(13)
  v_mfma_f32_16x16x32_bf16 v[228:231], v[124:127], v[160:163], v[228:231]
  buffer_load_dwordx4 v9, s[48:51], s67 offen offset:1024 lds
  ds_read_b64 v[124:125], v192 offset:3584
  ds_read_b64 v[126:127], v192 offset:3592
  v_mfma_f32_16x16x32_bf16 v[224:227], v[120:123], v[160:163], v[224:227]
  s_waitcnt vmcnt(8)
  ds_read_b64_tr_b16 a[56:57], v13 offset:2048
  ds_read_b64_tr_b16 a[58:59], v13 offset:2560
  s_waitcnt lgkmcnt(14)
  v_mfma_f32_16x16x32_bf16 v[228:231], v[120:123], v[164:167], v[228:231]
  ds_read_b64 v[120:121], v192 offset:3072
  ds_read_b64 v[122:123], v192 offset:3080
  v_mfma_f32_16x16x32_bf16 v[220:223], v[116:119], v[160:163], v[220:223]
  ds_read_b64_tr_b16 a[60:61], v14 offset:2048
  ds_read_b64_tr_b16 a[62:63], v14 offset:2560
  v_mfma_f32_16x16x32_bf16 v[224:227], v[116:119], v[164:167], v[224:227]
  s_waitcnt lgkmcnt(14)
  v_mfma_f32_16x16x32_bf16 v[228:231], v[116:119], v[168:171], v[228:231]
  s_waitcnt lgkmcnt(14)
  s_add_u32 m0, s61, 0
  s_add_u32 s67, s67, 65536
  buffer_load_dwordx4 v8, s[48:51], s67 offen lds
  ds_read_b64 v[116:117], v192 offset:2560
  ds_read_b64 v[118:119], v192 offset:2568
  v_mfma_f32_16x16x32_bf16 v[216:219], v[112:115], v[160:163], v[216:219]
  buffer_load_dwordx4 v9, s[48:51], s67 offen offset:1024 lds
  v_mfma_f32_16x16x32_bf16 v[220:223], v[112:115], v[164:167], v[220:223]
  v_mfma_f32_16x16x32_bf16 v[224:227], v[112:115], v[168:171], v[224:227]
  s_waitcnt vmcnt(8)
  ds_read_b64_tr_b16 a[64:65], v13 offset:4096
  ds_read_b64_tr_b16 a[66:67], v13 offset:4608
  v_mfma_f32_16x16x32_bf16 v[228:231], v[112:115], v[172:175], v[228:231]
  ds_read_b64 v[112:113], v192 offset:2048
  ds_read_b64 v[114:115], v192 offset:2056
  v_mfma_f32_16x16x32_bf16 v[212:215], v[108:111], v[160:163], v[212:215]
  ds_read_b64_tr_b16 a[68:69], v14 offset:4096
  ds_read_b64_tr_b16 a[70:71], v14 offset:4608
  v_mfma_f32_16x16x32_bf16 v[216:219], v[108:111], v[164:167], v[216:219]
  v_mfma_f32_16x16x32_bf16 v[220:223], v[108:111], v[168:171], v[220:223]
  s_waitcnt lgkmcnt(8)
  s_add_u32 m0, s61, 2048
  s_add_u32 s67, s67, 65536
  buffer_load_dwordx4 v8, s[48:51], s67 offen lds
  v_mfma_f32_16x16x32_bf16 v[224:227], v[108:111], v[172:175], v[224:227]
  buffer_load_dwordx4 v9, s[48:51], s67 offen offset:1024 lds
  v_mfma_f32_16x16x32_bf16 v[228:231], v[108:111], v[176:179], v[228:231]
  ds_read_b64 v[108:109], v192 offset:1536
  ds_read_b64 v[110:111], v192 offset:1544
  v_mfma_f32_16x16x32_bf16 v[208:211], v[104:107], v[160:163], v[208:211]
  s_waitcnt vmcnt(8)
  ds_read_b64_tr_b16 a[72:73], v13 offset:6144
  ds_read_b64_tr_b16 a[74:75], v13 offset:6656
  v_mfma_f32_16x16x32_bf16 v[212:215], v[104:107], v[164:167], v[212:215]
  v_mfma_f32_16x16x32_bf16 v[216:219], v[104:107], v[168:171], v[216:219]
  ds_read_b64_tr_b16 a[76:77], v14 offset:6144
  ds_read_b64_tr_b16 a[78:79], v14 offset:6656
  v_mfma_f32_16x16x32_bf16 v[220:223], v[104:107], v[172:175], v[220:223]
  s_waitcnt lgkmcnt(6)
  s_add_u32 m0, s61, 4096
  s_add_u32 s67, s67, 65536
  buffer_load_dwordx4 v8, s[48:51], s67 offen lds
  v_mfma_f32_16x16x32_bf16 v[224:227], v[104:107], v[176:179], v[224:227]
  v_mfma_f32_16x16x32_bf16 v[228:231], v[104:107], v[180:183], v[228:231]
  buffer_load_dwordx4 v9, s[48:51], s67 offen offset:1024 lds
  ds_read_b64 v[104:105], v192 offset:1024
  ds_read_b64 v[106:107], v192 offset:1032
  v_mfma_f32_16x16x32_bf16 v[204:207], v[100:103], v[160:163], v[204:207]
  v_mfma_f32_16x16x32_bf16 v[208:211], v[100:103], v[164:167], v[208:211]
  s_waitcnt vmcnt(8)
  ds_read_b64_tr_b16 a[80:81], v13 offset:8192
  ds_read_b64_tr_b16 a[82:83], v13 offset:8704
  v_mfma_f32_16x16x32_bf16 v[212:215], v[100:103], v[168:171], v[212:215]
  ds_read_b64_tr_b16 a[84:85], v14 offset:8192
  ds_read_b64_tr_b16 a[86:87], v14 offset:8704
  v_mfma_f32_16x16x32_bf16 v[216:219], v[100:103], v[172:175], v[216:219]
  v_mfma_f32_16x16x32_bf16 v[220:223], v[100:103], v[176:179], v[220:223]
  s_waitcnt lgkmcnt(6)
  s_add_u32 m0, s61, 6144
  s_add_u32 s67, s67, 65536
  buffer_load_dwordx4 v8, s[48:51], s67 offen lds
  v_mfma_f32_16x16x32_bf16 v[224:227], v[100:103], v[180:183], v[224:227]
  v_mfma_f32_16x16x32_bf16 v[228:231], v[100:103], v[184:187], v[228:231]
  buffer_load_dwordx4 v9, s[48:51], s67 offen offset:1024 lds
  ds_read_b64 v[100:101], v192 offset:512
  ds_read_b64 v[102:103], v192 offset:520
  v_mfma_f32_16x16x32_bf16 v[200:203], v[96:99], v[160:163], v[200:203]
  ds_read_b128 v[160:163], v193 offset:0
  v_mfma_f32_16x16x32_bf16 v[204:207], v[96:99], v[164:167], v[204:207]
  s_waitcnt vmcnt(8)
  ds_read_b64_tr_b16 a[88:89], v13 offset:10240
  ds_read_b64_tr_b16 a[90:91], v13 offset:10752
  ds_read_b128 v[164:167], v193 offset:512
  v_mfma_f32_16x16x32_bf16 v[208:211], v[96:99], v[168:171], v[208:211]
  ds_read_b64_tr_b16 a[92:93], v14 offset:10240
  ds_read_b64_tr_b16 a[94:95], v14 offset:10752
  ds_read_b128 v[168:171], v193 offset:1024
  v_mfma_f32_16x16x32_bf16 v[212:215], v[96:99], v[172:175], v[212:215]
  ds_read_b128 v[172:175], v193 offset:1536
  v_mfma_f32_16x16x32_bf16 v[216:219], v[96:99], v[176:179], v[216:219]
  s_waitcnt lgkmcnt(10)
  s_add_u32 m0, s61, 8192
  s_add_u32 s67, s67, 65536
  buffer_load_dwordx4 v8, s[48:51], s67 offen lds
  ds_read_b128 v[176:179], v193 offset:2048
  v_mfma_f32_16x16x32_bf16 v[220:223], v[96:99], v[180:183], v[220:223]
  ds_read_b128 v[180:183], v193 offset:2560
  v_mfma_f32_16x16x32_bf16 v[224:227], v[96:99], v[184:187], v[224:227]
  buffer_load_dwordx4 v9, s[48:51], s67 offen offset:1024 lds
  ds_read_b128 v[184:187], v193 offset:3072
  v_mfma_f32_16x16x32_bf16 v[228:231], v[96:99], v[188:191], v[228:231]
  s_waitcnt vmcnt(8)
  ds_read_b64_tr_b16 a[96:97], v13 offset:0
  ds_read_b64_tr_b16 a[98:99], v13 offset:512
  ds_read_b128 v[188:191], v193 offset:3584
  ds_read_b64 v[96:97], v192 offset:0
  ds_read_b64 v[98:99], v192 offset:8
  v_add_u32 v192, 64, v192
  v_subrev_u32 v193, 64, v193
  s_waitcnt lgkmcnt(14)
  v_mfma_f32_16x16x32_bf16 v[228:231], v[124:127], v[160:163], v[228:231]
  ds_read_b64 v[124:125], v192 offset:3584
  ds_read_b64 v[126:127], v192 offset:3592
  v_mfma_f32_16x16x32_bf16 v[224:227], v[120:123], v[160:163], v[224:227]
  ds_read_b64_tr_b16 a[100:101], v14 offset:0
  ds_read_b64_tr_b16 a[102:103], v14 offset:512
  s_waitcnt lgkmcnt(14)
  v_mfma_f32_16x16x32_bf16 v[228:231], v[120:123], v[164:167], v[228:231]
  ds_read_b64 v[120:121], v192 offset:3072
  ds_read_b64 v[122:123], v192 offset:3080
  v_mfma_f32_16x16x32_bf16 v[220:223], v[116:119], v[160:163], v[220:223]
  s_waitcnt lgkmcnt(14)
  s_add_u32 m0, s61, 10240
  s_add_u32 s67, s67, 65536
  buffer_load_dwordx4 v8, s[48:51], s67 offen lds
  v_mfma_f32_16x16x32_bf16 v[224:227], v[116:119], v[164:167], v[224:227]
  buffer_load_dwordx4 v9, s[48:51], s67 offen offset:1024 lds
  s_waitcnt lgkmcnt(14)
  v_mfma_f32_16x16x32_bf16 v[228:231], v[116:119], v[168:171], v[228:231]
  ds_read_b64 v[116:117], v192 offset:2560
  ds_read_b64 v[118:119], v192 offset:2568
  v_mfma_f32_16x16x32_bf16 v[216:219], v[112:115], v[160:163], v[216:219]
  s_waitcnt vmcnt(8)
  ds_read_b64_tr_b16 a[104:105], v13 offset:2048
  ds_read_b64_tr_b16 a[106:107], v13 offset:2560
  v_mfma_f32_16x16x32_bf16 v[220:223], v[112:115], v[164:167], v[220:223]
  v_mfma_f32_16x16x32_bf16 v[224:227], v[112:115], v[168:171], v[224:227]
  ds_read_b64_tr_b16 a[108:109], v14 offset:2048
  ds_read_b64_tr_b16 a[110:111], v14 offset:2560
  s_waitcnt lgkmcnt(14)
  v_mfma_f32_16x16x32_bf16 v[228:231], v[112:115], v[172:175], v[228:231]
  ds_read_b64 v[112:113], v192 offset:2048
  ds_read_b64 v[114:115], v192 offset:2056
  v_mfma_f32_16x16x32_bf16 v[212:215], v[108:111], v[160:163], v[212:215]
  s_waitcnt lgkmcnt(10)
  s_add_u32 m0, s61, 0
  s_add_u32 s67, s67, 65536
  buffer_load_dwordx4 v8, s[48:51], s67 offen lds
  v_mfma_f32_16x16x32_bf16 v[216:219], v[108:111], v[164:167], v[216:219]
  buffer_load_dwordx4 v9, s[48:51], s67 offen offset:1024 lds
  v_mfma_f32_16x16x32_bf16 v[220:223], v[108:111], v[168:171], v[220:223]
  v_mfma_f32_16x16x32_bf16 v[224:227], v[108:111], v[172:175], v[224:227]
  s_waitcnt vmcnt(8)
  ds_read_b64_tr_b16 a[112:113], v13 offset:4096
  ds_read_b64_tr_b16 a[114:115], v13 offset:4608
  v_mfma_f32_16x16x32_bf16 v[228:231], v[108:111], v[176:179], v[228:231]
  ds_read_b64 v[108:109], v192 offset:1536
  ds_read_b64 v[110:111], v192 offset:1544
  v_mfma_f32_16x16x32_bf16 v[208:211], v[104:107], v[160:163], v[208:211]
  ds_read_b64_tr_b16 a[116:117], v14 offset:4096
  ds_read_b64_tr_b16 a[118:119], v14 offset:4608
  v_mfma_f32_16x16x32_bf16 v[212:215], v[104:107], v[164:167], v[212:215]
  s_waitcnt lgkmcnt(8)
  s_add_u32 m0, s61, 2048
  s_add_u32 s67, s67, 65536
  buffer_load_dwordx4 v8, s[48:51], s67 offen lds
  v_mfma_f32_16x16x32_bf16 v[216:219], v[104:107], v[168:171], v[216:219]
  v_mfma_f32_16x16x32_bf16 v[220:223], v[104:107], v[172:175], v[220:223]
  buffer_load_dwordx4 v9, s[48:51], s67 offen offset:1024 lds
  v_mfma_f32_16x16x32_bf16 v[224:227], v[104:107], v[176:179], v[224:227]
  v_mfma_f32_16x16x32_bf16 v[228:231], v[104:107], v[180:183], v[228:231]
  s_waitcnt vmcnt(8)
  ds_read_b64_tr_b16 a[120:121], v13 offset:6144
  ds_read_b64_tr_b16 a[122:123], v13 offset:6656
  ds_read_b64 v[104:105], v192 offset:1024
  ds_read_b64 v[106:107], v192 offset:1032
  v_mfma_f32_16x16x32_bf16 v[204:207], v[100:103], v[160:163], v[204:207]
  ds_read_b64_tr_b16 a[124:125], v14 offset:6144
  ds_read_b64_tr_b16 a[126:127], v14 offset:6656
  v_mfma_f32_16x16x32_bf16 v[208:211], v[100:103], v[164:167], v[208:211]
  v_mfma_f32_16x16x32_bf16 v[212:215], v[100:103], v[168:171], v[212:215]
  s_waitcnt lgkmcnt(6)
  s_add_u32 m0, s61, 4096
  s_add_u32 s67, s67, 65536
  buffer_load_dwordx4 v8, s[48:51], s67 offen lds
  v_mfma_f32_16x16x32_bf16 v[216:219], v[100:103], v[172:175], v[216:219]
  v_mfma_f32_16x16x32_bf16 v[220:223], v[100:103], v[176:179], v[220:223]
  buffer_load_dwordx4 v9, s[48:51], s67 offen offset:1024 lds
  v_mfma_f32_16x16x32_bf16 v[224:227], v[100:103], v[180:183], v[224:227]
  v_mfma_f32_16x16x32_bf16 v[228:231], v[100:103], v[184:187], v[228:231]
  s_waitcnt vmcnt(8)
  ds_read_b64_tr_b16 a[128:129], v13 offset:8192
  ds_read_b64_tr_b16 a[130:131], v13 offset:8704
  ds_read_b64 v[100:101], v192 offset:512
  ds_read_b64 v[102:103], v192 offset:520
  v_mfma_f32_16x16x32_bf16 v[200:203], v[96:99], v[160:163], v[200:203]
  ds_read_b64_tr_b16 a[132:133], v14 offset:8192
  ds_read_b64_tr_b16 a[134:135], v14 offset:8704
  ds_read_b128 v[160:163], v193 offset:0
  v_mfma_f32_16x16x32_bf16 v[204:207], v[96:99], v[164:167], v[204:207]
  ds_read_b128 v[164:167], v193 offset:512
  v_mfma_f32_16x16x32_bf16 v[208:211], v[96:99], v[168:171], v[208:211]
  s_waitcnt lgkmcnt(8)
  s_add_u32 m0, s61, 6144
  s_add_u32 s67, s67, 65536
  buffer_load_dwordx4 v8, s[48:51], s67 offen lds
  ds_read_b128 v[168:171], v193 offset:1024
  v_mfma_f32_16x16x32_bf16 v[212:215], v[96:99], v[172:175], v[212:215]
  ds_read_b128 v[172:175], v193 offset:1536
  v_mfma_f32_16x16x32_bf16 v[216:219], v[96:99], v[176:179], v[216:219]
  buffer_load_dwordx4 v9, s[48:51], s67 offen offset:1024 lds
  ds_read_b128 v[176:179], v193 offset:2048
  v_mfma_f32_16x16x32_bf16 v[220:223], v[96:99], v[180:183], v[220:223]
  s_waitcnt vmcnt(8)
  ds_read_b64_tr_b16 a[136:137], v13 offset:10240
  ds_read_b64_tr_b16 a[138:139], v13 offset:10752
  ds_read_b128 v[180:183], v193 offset:2560
  v_mfma_f32_16x16x32_bf16 v[224:227], v[96:99], v[184:187], v[224:227]
  ds_read_b128 v[184:187], v193 offset:3072
  v_mfma_f32_16x16x32_bf16 v[228:231], v[96:99], v[188:191], v[228:231]
  ds_read_b64_tr_b16 a[140:141], v14 offset:10240
  ds_read_b64_tr_b16 a[142:143], v14 offset:10752
  ds_read_b128 v[188:191], v193 offset:3584
  ds_read_b64 v[96:97], v192 offset:0
  ds_read_b64 v[98:99], v192 offset:8
  s_waitcnt lgkmcnt(13)
  v_mfma_f32_16x16x32_bf16 v[228:231], v[124:127], v[160:163], v[228:231]
  v_mfma_f32_16x16x32_bf16 v[224:227], v[120:123], v[160:163], v[224:227]
  s_add_u32 m0, s61, 8192
  s_add_u32 s67, s67, 65536
  buffer_load_dwordx4 v8, s[48:51], s67 offen lds
  s_waitcnt lgkmcnt(12)
  v_mfma_f32_16x16x32_bf16 v[228:231], v[120:123], v[164:167], v[228:231]
  buffer_load_dwordx4 v9, s[48:51], s67 offen offset:1024 lds
  v_mfma_f32_16x16x32_bf16 v[220:223], v[116:119], v[160:163], v[220:223]
  v_mfma_f32_16x16x32_bf16 v[224:227], v[116:119], v[164:167], v[224:227]
  s_waitcnt vmcnt(8)
  ds_read_b64_tr_b16 a[144:145], v13 offset:0
  ds_read_b64_tr_b16 a[146:147], v13 offset:512
  s_waitcnt lgkmcnt(13)
  v_mfma_f32_16x16x32_bf16 v[228:231], v[116:119], v[168:171], v[228:231]
  buffer_load_dword v250, v23, s[32:35], 0 offen sc1
  v_mfma_f32_16x16x32_bf16 v[216:219], v[112:115], v[160:163], v[216:219]
  ds_read_b64_tr_b16 a[148:149], v14 offset:0
  ds_read_b64_tr_b16 a[150:151], v14 offset:512
  v_mfma_f32_16x16x32_bf16 v[220:223], v[112:115], v[164:167], v[220:223]
  v_mfma_f32_16x16x32_bf16 v[224:227], v[112:115], v[168:171], v[224:227]
  s_waitcnt lgkmcnt(7)
  s_add_u32 m0, s61, 10240
  s_add_u32 s67, s67, 65536
  buffer_load_dwordx4 v8, s[48:51], s67 offen lds
  v_mfma_f32_16x16x32_bf16 v[228:231], v[112:115], v[172:175], v[228:231]
  buffer_load_dwordx4 v9, s[48:51], s67 offen offset:1024 lds
  v_lshlrev_b32 v64, 16, v48
  v_mov_b32 v65, v64
  v_mov_b64 v[66:67], v[64:65]
  v_mov_b64 v[68:69], v[64:65]
  v_mov_b64 v[70:71], v[64:65]
  v_mov_b64 v[72:73], v[64:65]
  v_mov_b64 v[74:75], v[64:65]
  v_mov_b64 v[76:77], v[64:65]
  v_mov_b64 v[78:79], v[64:65]
  v_mfma_f32_16x16x32_bf16 v[212:215], v[108:111], v[160:163], v[212:215]
  v_mfma_f32_16x16x32_bf16 v[216:219], v[108:111], v[164:167], v[216:219]
  s_waitcnt vmcnt(9)
  ds_read_b64_tr_b16 a[152:153], v13 offset:2048
  ds_read_b64_tr_b16 a[154:155], v13 offset:2560
  v_mfma_f32_16x16x32_bf16 v[220:223], v[108:111], v[168:171], v[220:223]
  v_mfma_f32_16x16x32_bf16 v[224:227], v[108:111], v[172:175], v[224:227]
  ds_read_b64_tr_b16 a[156:157], v14 offset:2048
  ds_read_b64_tr_b16 a[158:159], v14 offset:2560
  v_mfma_f32_16x16x32_bf16 v[228:231], v[108:111], v[176:179], v[228:231]
  s_waitcnt lgkmcnt(4)
  s_add_u32 m0, s61, 0
  s_add_u32 s67, s67, 65536
  buffer_load_dwordx4 v8, s[48:51], s67 offen lds
  v_mfma_f32_16x16x32_bf16 v[208:211], v[104:107], v[160:163], v[208:211]
  v_mfma_f32_16x16x32_bf16 v[212:215], v[104:107], v[164:167], v[212:215]
  buffer_load_dwordx4 v9, s[48:51], s67 offen offset:1024 lds
  v_mfma_f32_16x16x32_bf16 v[216:219], v[104:107], v[168:171], v[216:219]
  v_mfma_f32_16x16x32_bf16 v[220:223], v[104:107], v[172:175], v[220:223]
  s_waitcnt vmcnt(9)
  ds_read_b64_tr_b16 a[160:161], v13 offset:4096
  ds_read_b64_tr_b16 a[162:163], v13 offset:4608
  v_mfma_f32_16x16x32_bf16 v[224:227], v[104:107], v[176:179], v[224:227]
  ds_read_b64_tr_b16 a[164:165], v14 offset:4096
  ds_read_b64_tr_b16 a[166:167], v14 offset:4608
  v_mfma_f32_16x16x32_bf16 v[228:231], v[104:107], v[180:183], v[228:231]
  v_mfma_f32_16x16x32_bf16 v[204:207], v[100:103], v[160:163], v[204:207]
  s_waitcnt lgkmcnt(4)
  s_add_u32 m0, s61, 2048
  s_add_u32 s67, s67, 65536
  buffer_load_dwordx4 v8, s[48:51], s67 offen lds
  v_mfma_f32_16x16x32_bf16 v[208:211], v[100:103], v[164:167], v[208:211]
  v_mfma_f32_16x16x32_bf16 v[212:215], v[100:103], v[168:171], v[212:215]
  buffer_load_dwordx4 v9, s[48:51], s67 offen offset:1024 lds
  v_mfma_f32_16x16x32_bf16 v[216:219], v[100:103], v[172:175], v[216:219]
  v_mfma_f32_16x16x32_bf16 v[220:223], v[100:103], v[176:179], v[220:223]
  s_waitcnt vmcnt(9)
  ds_read_b64_tr_b16 a[168:169], v13 offset:6144
  ds_read_b64_tr_b16 a[170:171], v13 offset:6656
  v_mfma_f32_16x16x32_bf16 v[224:227], v[100:103], v[180:183], v[224:227]
  ds_read_b64_tr_b16 a[172:173], v14 offset:6144
  ds_read_b64_tr_b16 a[174:175], v14 offset:6656
  v_mfma_f32_16x16x32_bf16 v[228:231], v[100:103], v[184:187], v[228:231]
  v_mfma_f32_16x16x32_bf16 v[200:203], v[96:99], v[160:163], v[200:203]
  s_waitcnt lgkmcnt(4)
  s_add_u32 m0, s61, 4096
  s_add_u32 s67, s67, 65536
  buffer_load_dwordx4 v8, s[48:51], s67 offen lds
  v_mfma_f32_16x16x32_bf16 v[204:207], v[96:99], v[164:167], v[204:207]
  v_mfma_f32_16x16x32_bf16 v[208:211], v[96:99], v[168:171], v[208:211]
  buffer_load_dwordx4 v9, s[48:51], s67 offen offset:1024 lds
  v_mfma_f32_16x16x32_bf16 v[212:215], v[96:99], v[172:175], v[212:215]
  s_waitcnt vmcnt(9)
  ds_read_b64_tr_b16 a[176:177], v13 offset:8192
  ds_read_b64_tr_b16 a[178:179], v13 offset:8704
  v_mfma_f32_16x16x32_bf16 v[216:219], v[96:99], v[176:179], v[216:219]
  v_mfma_f32_16x16x32_bf16 v[220:223], v[96:99], v[180:183], v[220:223]
  ds_read_b64_tr_b16 a[180:181], v14 offset:8192
  ds_read_b64_tr_b16 a[182:183], v14 offset:8704
  v_mfma_f32_16x16x32_bf16 v[224:227], v[96:99], v[184:187], v[224:227]
  v_mfma_f32_16x16x32_bf16 v[228:231], v[96:99], v[188:191], v[228:231]
  s_waitcnt lgkmcnt(4)
  s_add_u32 m0, s61, 6144
  s_add_u32 s67, s67, 65536
  buffer_load_dwordx4 v8, s[48:51], s67 offen lds
  s_lshl_b32 s96, s2, 2
  s_add_u32 s96, s96, s56
  s_lshl_b32 s96, s96, 7
  s_add_u32 s96, s96, 0xa40000
  s_mul_i32 s68, s56, 401408
  s_lshl_b32 s62, s87, 10
  s_add_u32 s68, s68, s62
  s_add_u32 s70, s68, 0x500000
  s_add_u32 s71, s70, 401408
  s_mul_i32 s68, s95, 14336
  s_add_u32 s68, s68, s70
  s_lshl_b32 s62, s87, 6
  s_lshl_b32 s63, s56, 4
  s_add_u32 s62, s62, s63
  s_lshl_b32 s64, s62, 12
  s_lshl_b32 s63, s86, 7
  s_add_u32 s64, s64, s63
  s_add_u32 s64, s64, 0x800000
  s_lshl_b32 s62, s62, 1
  s_lshr_b32 s63, s86, 5
  s_add_u32 s62, s62, s63
  s_lshl_b32 s62, s62, 7
  s_add_u32 s62, s62, 0xa40000
  v_and_b32 v7, 14, v1
  v_lshlrev_b32 v7, 8, v7
  v_add_u32 v7, s62, v7
  s_waitcnt vmcnt(9)
  s_mov_b32 s60, 0
  s_branch L_P10_C
L_P10_L:
  s_sleep 2
  buffer_load_dword v250, v23, s[32:35], 0 offen sc1
  s_waitcnt vmcnt(0)
L_P10_C:
  v_cmp_ne_u32 vcc, v255, v250
  s_and_b64 exec, exec, vcc
  s_cbranch_scc0 L_P10_OK
  s_add_u32 s60, s60, 1
  s_cmp_lt_u32 s60, 0x8000
  s_cbranch_scc1 L_P10_L
L_P10_OK:
  s_mov_b64 exec, -1
  buffer_load_dwordx4 v[128:131], v16, s[32:35], s68 offen sc1
  buffer_load_dwordx4 v[132:135], v17, s[32:35], s68 offen sc1
  s_add_u32 s68, s68, 14336
  buffer_load_dwordx4 v[136:139], v16, s[32:35], s68 offen sc1
  buffer_load_dwordx4 v[140:143], v17, s[32:35], s68 offen sc1
  s_add_u32 s68, s68, 14336
  buffer_load_dwordx4 v[144:147], v16, s[32:35], s68 offen sc1
  buffer_load_dwordx4 v[148:151], v17, s[32:35], s68 offen sc1
  s_add_u32 s68, s68, 14336
  buffer_load_dwordx4 v[152:155], v16, s[32:35], s68 offen sc1
  buffer_load_dwordx4 v[156:159], v17, s[32:35], s68 offen sc1
  s_add_u32 s68, s68, 14336
  buffer_load_dwordx4 v[160:163], v16, s[32:35], s68 offen sc1
  buffer_load_dwordx4 v[164:167], v17, s[32:35], s68 offen sc1
  s_add_u32 s68, s68, 14336
  buffer_load_dwordx4 v[168:171], v16, s[32:35], s68 offen sc1
  buffer_load_dwordx4 v[172:175], v17, s[32:35], s68 offen sc1
  s_add_u32 s68, s68, 14336
  buffer_load_dwordx4 v[176:179], v16, s[32:35], s68 offen sc1
  buffer_load_dwordx4 v[180:183], v17, s[32:35], s68 offen sc1
  v_xor_b32 v4, 16384, v15
  s_bitcmp1_b32 s56, 0
  s_nop 5
  s_cbranch_scc1 L_ZX1
  ds_write_b128 v4, v[216:219] offset:0
  ds_write_b128 v4, v[220:223] offset:1024
  ds_write_b128 v4, v[224:227] offset:2048
  ds_write_b128 v4, v[228:231] offset:3072
  s_branch L_ZX2
L_ZX1:
  ds_write_b128 v4, v[200:203] offset:0
  ds_write_b128 v4, v[204:207] offset:1024
  ds_write_b128 v4, v[208:211] offset:2048
  ds_write_b128 v4, v[212:215] offset:3072
L_ZX2:
  buffer_load_dwordx4 v9, s[48:51], s67 offen offset:1024 lds
  s_waitcnt vmcnt(22)
  ds_read_b64_tr_b16 a[184:185], v13 offset:10240
  ds_read_b64_tr_b16 a[186:187], v13 offset:10752
  ds_read_b64_tr_b16 a[188:189], v14 offset:10240
  ds_read_b64_tr_b16 a[190:191], v14 offset:10752
  s_waitcnt vmcnt(20)
  ds_read_b64_tr_b16 a[192:193], v13 offset:0
  ds_read_b64_tr_b16 a[194:195], v13 offset:512
  s_waitcnt lgkmcnt(6)
  s_barrier
  ds_read_b128 v[232:235], v15 offset:0
  ds_read_b128 v[236:239], v15 offset:1024
  ds_read_b128 v[240:243], v15 offset:2048
  ds_read_b128 v[244:247], v15 offset:3072
  s_bitcmp1_b32 s56, 0
  s_cbranch_scc0 L_ZX3
  v_mov_b64 v[200:201], v[216:217]
  v_mov_b64 v[202:203], v[218:219]
  v_mov_b64 v[204:205], v[220:221]
  v_mov_b64 v[206:207], v[222:223]
  v_mov_b64 v[208:209], v[224:225]
  v_mov_b64 v[210:211], v[226:227]
  v_mov_b64 v[212:213], v[228:229]
  v_mov_b64 v[214:215], v[230:231]
L_ZX3:
  s_waitcnt lgkmcnt(3)
  v_pk_add_f32 v[200:201], v[200:201], v[232:233]
  v_pk_add_f32 v[202:203], v[202:203], v[234:235]
  v_cvt_pk_bf16_f32 v216, v200, v201
  v_cvt_pk_bf16_f32 v217, v202, v203
  s_waitcnt lgkmcnt(2)
  v_pk_add_f32 v[204:205], v[204:205], v[236:237]
  v_pk_add_f32 v[206:207], v[206:207], v[238:239]
  v_cvt_pk_bf16_f32 v218, v204, v205
  v_cvt_pk_bf16_f32 v219, v206, v207
  s_nop 1
  v_permlane16_swap_b32 v216, v218
  v_permlane16_swap_b32 v217, v219
  buffer_store_dwordx4 v[216:219], v194, s[32:35], s69 offen offset:0 sc1
  s_waitcnt lgkmcnt(1)
  v_pk_add_f32 v[208:209], v[208:209], v[240:241]
  v_pk_add_f32 v[210:211], v[210:211], v[242:243]
  v_cvt_pk_bf16_f32 v220, v208, v209
  v_cvt_pk_bf16_f32 v221, v210, v211
  s_waitcnt lgkmcnt(0)
  v_pk_add_f32 v[212:213], v[212:213], v[244:245]
  v_pk_add_f32 v[214:215], v[214:215], v[246:247]
  v_cvt_pk_bf16_f32 v222, v212, v213
  v_cvt_pk_bf16_f32 v223, v214, v215
  s_nop 1
  v_permlane16_swap_b32 v220, v222
  v_permlane16_swap_b32 v221, v223
  buffer_store_dwordx4 v[220:223], v194, s[32:35], s69 offen offset:1024 sc1
  s_waitcnt vmcnt(15)
  v_mfma_f32_32x32x16_bf16 v[64:79], v[128:131], a[0:3], v[64:79]
  s_add_u32 s68, s68, 14336
  buffer_load_dwordx4 v[184:187], v16, s[32:35], s68 offen sc1
  v_mfma_f32_32x32x16_bf16 v[80:95], v[132:135], a[0:3], 0
  ds_read_b64_tr_b16 a[196:197], v14 offset:0
  ds_read_b64_tr_b16 a[198:199], v14 offset:512
  ds_read_b64_tr_b16 a[200:201], v13 offset:2048
  ds_read_b64_tr_b16 a[202:203], v13 offset:2560
  v_mfma_f32_32x32x16_bf16 v[96:111], v[128:131], a[4:7], 0
  buffer_load_dwordx4 v[188:191], v17, s[32:35], s68 offen sc1
  v_mfma_f32_32x32x16_bf16 v[112:127], v[132:135], a[4:7], 0
  ds_read_b64_tr_b16 a[204:205], v14 offset:2048
  ds_read_b64_tr_b16 a[206:207], v14 offset:2560
  ds_read_b64_tr_b16 a[208:209], v13 offset:4096
  ds_read_b64_tr_b16 a[210:211], v13 offset:4608
  s_waitcnt vmcnt(15)
  v_mfma_f32_32x32x16_bf16 v[64:79], v[136:139], a[8:11], v[64:79]
  s_add_u32 s68, s68, 14336
  buffer_load_dwordx4 v[128:131], v16, s[32:35], s68 offen sc1
  v_mfma_f32_32x32x16_bf16 v[80:95], v[140:143], a[8:11], v[80:95]
  ds_read_b64_tr_b16 a[212:213], v14 offset:4096
  ds_read_b64_tr_b16 a[214:215], v14 offset:4608
  s_waitcnt vmcnt(5)
  ds_read_b64_tr_b16 a[216:217], v13 offset:6144
  ds_read_b64_tr_b16 a[218:219], v13 offset:6656
  v_mfma_f32_32x32x16_bf16 v[96:111], v[136:139], a[12:15], v[96:111]
  buffer_load_dwordx4 v[132:135], v17, s[32:35], s68 offen sc1
  v_mfma_f32_32x32x16_bf16 v[112:127], v[140:143], a[12:15], v[112:127]
  ds_read_b64_tr_b16 a[220:221], v14 offset:6144
  ds_read_b64_tr_b16 a[222:223], v14 offset:6656
  v_mfma_f32_32x32x16_bf16 v[64:79], v[144:147], a[16:19], v[64:79]
  s_add_u32 s68, s68, 14336
  buffer_load_dwordx4 v[136:139], v16, s[32:35], s68 offen sc1
  v_mfma_f32_32x32x16_bf16 v[80:95], v[148:151], a[16:19], v[80:95]
  v_mfma_f32_32x32x16_bf16 v[96:111], v[144:147], a[20:23], v[96:111]
  buffer_load_dwordx4 v[140:143], v17, s[32:35], s68 offen sc1
  v_mfma_f32_32x32x16_bf16 v[112:127], v[148:151], a[20:23], v[112:127]
  v_mfma_f32_32x32x16_bf16 v[64:79], v[152:155], a[24:27], v[64:79]
  s_add_u32 s68, s68, 14336
  buffer_load_dwordx4 v[144:147], v16, s[32:35], s68 offen sc1
  v_mfma_f32_32x32x16_bf16 v[80:95], v[156:159], a[24:27], v[80:95]
  v_mfma_f32_32x32x16_bf16 v[96:111], v[152:155], a[28:31], v[96:111]
  buffer_load_dwordx4 v[148:151], v17, s[32:35], s68 offen sc1
  v_mfma_f32_32x32x16_bf16 v[112:127], v[156:159], a[28:31], v[112:127]
  v_mfma_f32_32x32x16_bf16 v[64:79], v[160:163], a[32:35], v[64:79]
  s_add_u32 s68, s68, 14336
  buffer_load_dwordx4 v[152:155], v16, s[32:35], s68 offen sc1
  v_mfma_f32_32x32x16_bf16 v[80:95], v[164:167], a[32:35], v[80:95]
  v_mfma_f32_32x32x16_bf16 v[96:111], v[160:163], a[36:39], v[96:111]
  buffer_load_dwordx4 v[156:159], v17, s[32:35], s68 offen sc1
  v_mfma_f32_32x32x16_bf16 v[112:127], v[164:167], a[36:39], v[112:127]
  v_mfma_f32_32x32x16_bf16 v[64:79], v[168:171], a[40:43], v[64:79]
  s_add_u32 s68, s68, 14336
  buffer_load_dwordx4 v[160:163], v16, s[32:35], s68 offen sc1
  v_mfma_f32_32x32x16_bf16 v[80:95], v[172:175], a[40:43], v[80:95]
  v_mfma_f32_32x32x16_bf16 v[96:111], v[168:171], a[44:47], v[96:111]
  buffer_load_dwordx4 v[164:167], v17, s[32:35], s68 offen sc1
  v_mfma_f32_32x32x16_bf16 v[112:127], v[172:175], a[44:47], v[112:127]
  v_mfma_f32_32x32x16_bf16 v[64:79], v[176:179], a[48:51], v[64:79]
  s_add_u32 s68, s68, 14336
  buffer_load_dwordx4 v[168:171], v16, s[32:35], s68 offen sc1
  v_mfma_f32_32x32x16_bf16 v[80:95], v[180:183], a[48:51], v[80:95]
  v_mfma_f32_32x32x16_bf16 v[96:111], v[176:179], a[52:55], v[96:111]
  buffer_load_dwordx4 v[172:175], v17, s[32:35], s68 offen sc1
  v_mfma_f32_32x32x16_bf16 v[112:127], v[180:183], a[52:55], v[112:127]
  s_waitcnt vmcnt(12)
  v_mfma_f32_32x32x16_bf16 v[64:79], v[184:187], a[56:59], v[64:79]
  s_add_u32 s68, s68, 14336
  buffer_load_dwordx4 v[176:179], v16, s[32:35], s68 offen sc1
  s_barrier
  s_cmp_lg_u32 s56, 0
  s_cbranch_scc1 L_ZF11
  v_mov_b32 v249, s96
  s_mov_b64 exec, 1
  buffer_store_dword v255, v249, s[32:35], 0 offen sc1
  s_mov_b64 exec, -1
L_ZF11:
  v_mfma_f32_32x32x16_bf16 v[80:95], v[188:191], a[56:59], v[80:95]
  v_permlane32_swap_b32 v40, v42
  v_permlane32_swap_b32 v41, v43
  v_permlane32_swap_b32 v44, v46
  v_permlane32_swap_b32 v45, v47
  v_mul_f32 v50, v50, v51
  v_mfma_f32_32x32x16_bf16 v[96:111], v[184:187], a[60:63], v[96:111]
  buffer_load_dwordx4 v[180:183], v17, s[32:35], s68 offen sc1
  v_lshlrev_b32 v200, 16, v40
  v_and_b32 v201, s59, v40
  v_fma_f32 v216, v200, v51, -v50
  v_fma_f32 v217, v201, v51, -v50
  v_mfma_f32_32x32x16_bf16 v[112:127], v[188:191], a[60:63], v[112:127]
  v_lshlrev_b32 v202, 16, v41
  v_and_b32 v203, s59, v41
  v_fma_f32 v218, v202, v51, -v50
  v_fma_f32 v219, v203, v51, -v50
  s_waitcnt vmcnt(12)
  v_mfma_f32_32x32x16_bf16 v[64:79], v[128:131], a[64:67], v[64:79]
  s_add_u32 s68, s68, 14336
  buffer_load_dwordx4 v[184:187], v16, s[32:35], s68 offen sc1
  v_lshlrev_b32 v204, 16, v42
  v_and_b32 v205, s59, v42
  v_fma_f32 v220, v204, v51, -v50
  v_fma_f32 v221, v205, v51, -v50
  v_mfma_f32_32x32x16_bf16 v[80:95], v[132:135], a[64:67], v[80:95]
  v_lshlrev_b32 v206, 16, v43
  v_and_b32 v207, s59, v43
  v_fma_f32 v222, v206, v51, -v50
  v_fma_f32 v223, v207, v51, -v50
  v_mfma_f32_32x32x16_bf16 v[96:111], v[128:131], a[68:71], v[96:111]
  buffer_load_dwordx4 v[188:191], v17, s[32:35], s68 offen sc1
  v_lshlrev_b32 v208, 16, v44
  v_and_b32 v209, s59, v44
  v_fma_f32 v224, v208, v51, -v50
  v_fma_f32 v225, v209, v51, -v50
  v_mfma_f32_32x32x16_bf16 v[112:127], v[132:135], a[68:71], v[112:127]
  v_lshlrev_b32 v210, 16, v45
  v_and_b32 v211, s59, v45
  v_fma_f32 v226, v210, v51, -v50
  v_fma_f32 v227, v211, v51, -v50
  s_waitcnt vmcnt(12)
  v_mfma_f32_32x32x16_bf16 v[64:79], v[136:139], a[72:75], v[64:79]
  s_add_u32 s68, s68, 14336
  buffer_load_dwordx4 v[128:131], v16, s[32:35], s68 offen sc1
  v_lshlrev_b32 v212, 16, v46
  v_and_b32 v213, s59, v46
  v_fma_f32 v228, v212, v51, -v50
  v_fma_f32 v229, v213, v51, -v50
  v_mfma_f32_32x32x16_bf16 v[80:95], v[140:143], a[72:75], v[80:95]
  v_lshlrev_b32 v214, 16, v47
  v_and_b32 v215, s59, v47
  v_fma_f32 v230, v214, v51, -v50
  v_fma_f32 v231, v215, v51, -v50
  v_mfma_f32_32x32x16_bf16 v[96:111], v[136:139], a[76:79], v[96:111]
  buffer_load_dwordx4 v[132:135], v17, s[32:35], s68 offen sc1
  s_mov_b32 s36, s26
  s_mov_b32 s37, s27
  s_mov_b32 s38, 0x1c0000
  s_mov_b32 s39, 0x20000
  v_mfma_f32_32x32x16_bf16 v[112:127], v[140:143], a[76:79], v[112:127]
  v_lshlrev_b32 v53, 9, v5
  v_sub_u32 v53, v21, v53
  s_and_b32 s72, s56, 1
  s_mul_i32 s72, s72, 24576
  s_waitcnt vmcnt(12)
  v_mfma_f32_32x32x16_bf16 v[64:79], v[144:147], a[80:83], v[64:79]
  s_add_u32 s68, s68, 14336
  buffer_load_dwordx4 v[136:139], v16, s[32:35], s68 offen sc1
  s_add_u32 s72, s72, 65536
  v_add_u32 v53, s72, v53
  s_lshr_b32 s72, s56, 1
  s_lshl_b32 s72, s72, 12
  v_mfma_f32_32x32x16_bf16 v[80:95], v[148:151], a[80:83], v[80:95]
  s_add_u32 s72, s72, 114688
  s_and_b32 s73, s56, 1
  s_lshl_b32 s73, s73, 2
  v_add_u32 v54, s73, v5
  v_mfma_f32_32x32x16_bf16 v[96:111], v[144:147], a[84:87], v[96:111]
  buffer_load_dwordx4 v[140:143], v17, s[32:35], s68 offen sc1
  v_and_b32 v55, 7, v6
  v_xor_b32 v54, v54, v55
  v_lshlrev_b32 v54, 4, v54
  v_lshl_add_u32 v54, v6, 7, v54
  v_mfma_f32_32x32x16_bf16 v[112:127], v[148:151], a[84:87], v[112:127]
  v_add_u32 v54, s72, v54
  v_xor_b32 v55, 32, v54
  s_lshl_b32 s72, s56, 11
  s_add_u32 s72, s72, 114688
  s_waitcnt vmcnt(12)
  v_mfma_f32_32x32x16_bf16 v[64:79], v[152:155], a[88:91], v[64:79]
  s_add_u32 s68, s68, 14336
  buffer_load_dwordx4 v[144:147], v16, s[32:35], s68 offen sc1
  v_lshlrev_b32 v30, 4, v1
  v_add_u32 v30, s72, v30
  v_and_b32 v31, 7, v1
  v_xor_b32 v31, v31, v2
  v_mfma_f32_32x32x16_bf16 v[80:95], v[156:159], a[88:91], v[80:95]
  v_lshlrev_b32 v31, 4, v31
  v_mul_u32_u24 v29, 896, v2
  v_add_u32 v31, v31, v29
  s_lshl_b32 s72, s86, 6
  v_mfma_f32_32x32x16_bf16 v[96:111], v[152:155], a[92:95], v[96:111]
  buffer_load_dwordx4 v[148:151], v17, s[32:35], s68 offen sc1
  s_lshl_b32 s73, s56, 4
  s_add_u32 s72, s72, s73
  s_mul_i32 s72, s72, 896
  s_lshl_b32 s73, s87, 7
  v_mfma_f32_32x32x16_bf16 v[112:127], v[156:159], a[92:95], v[112:127]
  s_add_u32 s72, s72, s73
  s_add_u32 s73, s72, 7168
  s_waitcnt vmcnt(12)
  v_mfma_f32_32x32x16_bf16 v[64:79], v[160:163], a[96:99], v[64:79]
  s_add_u32 s68, s68, 14336
  buffer_load_dwordx4 v[152:155], v16, s[32:35], s68 offen sc1
  v_mfma_f32_32x32x16_bf16 v[80:95], v[164:167], a[96:99], v[80:95]
  v_mfma_f32_32x32x16_bf16 v[96:111], v[160:163], a[100:103], v[96:111]
  buffer_load_dwordx4 v[156:159], v17, s[32:35], s68 offen sc1
  v_mfma_f32_32x32x16_bf16 v[112:127], v[164:167], a[100:103], v[112:127]
  s_waitcnt vmcnt(12)
  v_mfma_f32_32x32x16_bf16 v[64:79], v[168:171], a[104:107], v[64:79]
  s_add_u32 s68, s68, 14336
  buffer_load_dwordx4 v[160:163], v16, s[32:35], s68 offen sc1
  v_mfma_f32_32x32x16_bf16 v[80:95], v[172:175], a[104:107], v[80:95]
  v_mfma_f32_32x32x16_bf16 v[96:111], v[168:171], a[108:111], v[96:111]
  buffer_load_dwordx4 v[164:167], v17, s[32:35], s68 offen sc1
  v_mfma_f32_32x32x16_bf16 v[112:127], v[172:175], a[108:111], v[112:127]
  s_waitcnt vmcnt(12)
  v_mfma_f32_32x32x16_bf16 v[64:79], v[176:179], a[112:115], v[64:79]
  s_add_u32 s68, s68, 14336
  buffer_load_dwordx4 v[168:171], v16, s[32:35], s68 offen sc1
  v_mfma_f32_32x32x16_bf16 v[80:95], v[180:183], a[112:115], v[80:95]
  v_mfma_f32_32x32x16_bf16 v[96:111], v[176:179], a[116:119], v[96:111]
  buffer_load_dwordx4 v[172:175], v17, s[32:35], s68 offen sc1
  v_mfma_f32_32x32x16_bf16 v[112:127], v[180:183], a[116:119], v[112:127]
  s_waitcnt vmcnt(12)
  v_mfma_f32_32x32x16_bf16 v[64:79], v[184:187], a[120:123], v[64:79]
  s_add_u32 s68, s68, 14336
  buffer_load_dwordx4 v[176:179], v16, s[32:35], s68 offen sc1
  v_mfma_f32_32x32x16_bf16 v[80:95], v[188:191], a[120:123], v[80:95]
  v_mfma_f32_32x32x16_bf16 v[96:111], v[184:187], a[124:127], v[96:111]
  buffer_load_dwordx4 v[180:183], v17, s[32:35], s68 offen sc1
  v_mfma_f32_32x32x16_bf16 v[112:127], v[188:191], a[124:127], v[112:127]
  s_waitcnt vmcnt(12)
  v_mfma_f32_32x32x16_bf16 v[64:79], v[128:131], a[128:131], v[64:79]
  s_add_u32 s68, s68, 14336
  buffer_load_dwordx4 v[184:187], v16, s[32:35], s68 offen sc1
  v_mfma_f32_32x32x16_bf16 v[80:95], v[132:135], a[128:131], v[80:95]
  v_mfma_f32_32x32x16_bf16 v[96:111], v[128:131], a[132:135], v[96:111]
  buffer_load_dwordx4 v[188:191], v17, s[32:35], s68 offen sc1
  v_mfma_f32_32x32x16_bf16 v[112:127], v[132:135], a[132:135], v[112:127]
  s_waitcnt vmcnt(12)
  v_mfma_f32_32x32x16_bf16 v[64:79], v[136:139], a[136:139], v[64:79]
  s_add_u32 s68, s68, 14336
  buffer_load_dwordx4 v[128:131], v16, s[32:35], s68 offen sc1
  v_mfma_f32_32x32x16_bf16 v[80:95], v[140:143], a[136:139], v[80:95]
  v_mfma_f32_32x32x16_bf16 v[96:111], v[136:139], a[140:143], v[96:111]
  buffer_load_dwordx4 v[132:135], v17, s[32:35], s68 offen sc1
  v_mfma_f32_32x32x16_bf16 v[112:127], v[140:143], a[140:143], v[112:127]
  s_waitcnt vmcnt(12)
  v_mfma_f32_32x32x16_bf16 v[64:79], v[144:147], a[144:147], v[64:79]
  s_add_u32 s68, s68, 14336
  buffer_load_dwordx4 v[136:139], v16, s[32:35], s68 offen sc1
  buffer_load_dword v250, v7, s[32:35], 0 offen sc1
  v_mfma_f32_32x32x16_bf16 v[80:95], v[148:151], a[144:147], v[80:95]
  v_mfma_f32_32x32x16_bf16 v[96:111], v[144:147], a[148:151], v[96:111]
  buffer_load_dwordx4 v[140:143], v17, s[32:35], s68 offen sc1
  v_mfma_f32_32x32x16_bf16 v[112:127], v[148:151], a[148:151], v[112:127]
  s_waitcnt vmcnt(13)
  v_mfma_f32_32x32x16_bf16 v[64:79], v[152:155], a[152:155], v[64:79]
  s_add_u32 s68, s68, 14336
  buffer_load_dwordx4 v[144:147], v16, s[32:35], s68 offen sc1
  v_mfma_f32_32x32x16_bf16 v[80:95], v[156:159], a[152:155], v[80:95]
  v_mfma_f32_32x32x16_bf16 v[96:111], v[152:155], a[156:159], v[96:111]
  buffer_load_dwordx4 v[148:151], v17, s[32:35], s68 offen sc1
  v_mfma_f32_32x32x16_bf16 v[112:127], v[156:159], a[156:159], v[112:127]
  s_waitcnt vmcnt(13)
  v_mfma_f32_32x32x16_bf16 v[64:79], v[160:163], a[160:163], v[64:79]
  s_add_u32 s68, s68, 14336
  buffer_load_dwordx4 v[152:155], v16, s[32:35], s68 offen sc1
  v_mfma_f32_32x32x16_bf16 v[80:95], v[164:167], a[160:163], v[80:95]
  v_mfma_f32_32x32x16_bf16 v[96:111], v[160:163], a[164:167], v[96:111]
  buffer_load_dwordx4 v[156:159], v17, s[32:35], s68 offen sc1
  v_mfma_f32_32x32x16_bf16 v[112:127], v[164:167], a[164:167], v[112:127]
  s_waitcnt vmcnt(13)
  v_mfma_f32_32x32x16_bf16 v[64:79], v[168:171], a[168:171], v[64:79]
  v_mfma_f32_32x32x16_bf16 v[80:95], v[172:175], a[168:171], v[80:95]
  v_mfma_f32_32x32x16_bf16 v[96:111], v[168:171], a[172:175], v[96:111]
  v_mfma_f32_32x32x16_bf16 v[112:127], v[172:175], a[172:175], v[112:127]
  s_waitcnt vmcnt(11)
  v_mfma_f32_32x32x16_bf16 v[64:79], v[176:179], a[176:179], v[64:79]
  s_waitcnt vmcnt(5)
  s_mov_b32 s60, 0
  s_branch L_P12_C
L_P12_L:
  s_sleep 2
  buffer_load_dword v250, v7, s[32:35], 0 offen sc1
  s_waitcnt vmcnt(0)
L_P12_C:
  v_cmp_ne_u32 vcc, v255, v250
  s_and_b64 exec, exec, vcc
  s_cbranch_scc0 L_P12_OK
  s_add_u32 s60, s60, 1
  s_cmp_lt_u32 s60, 0x8000
  s_cbranch_scc1 L_P12_L
L_P12_OK:
  s_mov_b64 exec, -1
  s_waitcnt lgkmcnt(0)
  s_mov_b32 m0, s61
  s_nop 0
  buffer_load_dwordx4 v8, s[32:35], s64 offen sc1 lds
  v_mfma_f32_32x32x16_bf16 v[80:95], v[180:183], a[176:179], v[80:95]
  v_mfma_f32_32x32x16_bf16 v[96:111], v[176:179], a[180:183], v[96:111]
  buffer_load_dwordx4 v9, s[32:35], s64 offen offset:1024 sc1 lds
  v_mfma_f32_32x32x16_bf16 v[112:127], v[180:183], a[180:183], v[112:127]
  v_mfma_f32_32x32x16_bf16 v[64:79], v[184:187], a[184:187], v[64:79]
  v_mfma_f32_32x32x16_bf16 v[80:95], v[188:191], a[184:187], v[80:95]
  v_mfma_f32_32x32x16_bf16 v[96:111], v[184:187], a[188:191], v[96:111]
  v_mfma_f32_32x32x16_bf16 v[112:127], v[188:191], a[188:191], v[112:127]
  v_mfma_f32_32x32x16_bf16 v[112:127], v[132:135], a[196:199], v[112:127]
  s_waitcnt vmcnt(6)
  v_mfma_f32_32x32x16_bf16 v[112:127], v[140:143], a[204:207], v[112:127]
  s_waitcnt vmcnt(4)
  v_mfma_f32_32x32x16_bf16 v[112:127], v[148:151], a[212:215], v[112:127]
  s_waitcnt vmcnt(2)
  v_mfma_f32_32x32x16_bf16 v[112:127], v[156:159], a[220:223], v[112:127]
  v_mfma_f32_32x32x16_bf16 v[96:111], v[128:131], a[196:199], v[96:111]
  v_mfma_f32_32x32x16_bf16 v[96:111], v[136:139], a[204:207], v[96:111]
  s_nop 9
  ds_write_b128 v20, v[112:115] offset:0
  ds_write_b128 v20, v[116:119] offset:1024
  ds_write_b128 v20, v[120:123] offset:2048
  ds_write_b128 v20, v[124:127] offset:3072
  v_mfma_f32_32x32x16_bf16 v[96:111], v[144:147], a[212:215], v[96:111]
  v_mfma_f32_32x32x16_bf16 v[96:111], v[152:155], a[220:223], v[96:111]
  v_mfma_f32_32x32x16_bf16 v[80:95], v[132:135], a[192:195], v[80:95]
  v_mfma_f32_32x32x16_bf16 v[80:95], v[140:143], a[200:203], v[80:95]
  s_nop 9
  ds_write_b128 v19, v[96:99] offset:0
  ds_write_b128 v19, v[100:103] offset:1024
  ds_write_b128 v19, v[104:107] offset:2048
  ds_write_b128 v19, v[108:111] offset:3072
  v_mfma_f32_32x32x16_bf16 v[80:95], v[148:151], a[208:211], v[80:95]
  v_mfma_f32_32x32x16_bf16 v[80:95], v[156:159], a[216:219], v[80:95]
  v_mfma_f32_32x32x16_bf16 v[64:79], v[128:131], a[192:195], v[64:79]
  v_mfma_f32_32x32x16_bf16 v[64:79], v[136:139], a[200:203], v[64:79]
  s_nop 9
  ds_write_b128 v18, v[80:83] offset:0
  ds_write_b128 v18, v[84:87] offset:1024
  ds_write_b128 v18, v[88:91] offset:2048
  ds_write_b128 v18, v[92:95] offset:3072
  v_mfma_f32_32x32x16_bf16 v[64:79], v[144:147], a[208:211], v[64:79]
  v_mfma_f32_32x32x16_bf16 v[64:79], v[152:155], a[216:219], v[64:79]
  s_mov_b32 s62, 0xbfb8aa3b
  s_waitcnt vmcnt(0)
  s_waitcnt lgkmcnt(0)
  s_barrier
  ds_read_b64_tr_b16 v[32:33], v53 offset:0
  ds_read_b64_tr_b16 v[34:35], v53 offset:1024
  ds_read_b64_tr_b16 v[36:37], v53 offset:12288
  ds_read_b64_tr_b16 v[38:39], v53 offset:13312
  ds_read_b128 v[80:83], v15 offset:4096
  ds_read_b128 v[96:99], v15 offset:8192
  ds_read_b128 v[112:115], v15 offset:12288
  ds_read_b128 v[84:87], v15 offset:5120
  ds_read_b128 v[100:103], v15 offset:9216
  ds_read_b128 v[116:119], v15 offset:13312
  ds_read_b128 v[88:91], v15 offset:6144
  ds_read_b128 v[104:107], v15 offset:10240
  ds_read_b128 v[120:123], v15 offset:14336
  ds_read_b128 v[92:95], v15 offset:7168
  ds_read_b128 v[108:111], v15 offset:11264
  ds_read_b128 v[124:127], v15 offset:15360
  s_waitcnt lgkmcnt(14)
  v_lshlrev_b32 v40, 16, v32
  v_and_b32 v41, s59, v32
  v_pk_mul_f32 v[216:217], v[40:41], v[216:217]
  v_lshlrev_b32 v40, 16, v33
  v_and_b32 v41, s59, v33
  v_pk_mul_f32 v[218:219], v[40:41], v[218:219]
  s_waitcnt lgkmcnt(14)
  v_lshlrev_b32 v40, 16, v34
  v_and_b32 v41, s59, v34
  v_pk_mul_f32 v[220:221], v[40:41], v[220:221]
  v_lshlrev_b32 v40, 16, v35
  v_and_b32 v41, s59, v35
  v_pk_mul_f32 v[222:223], v[40:41], v[222:223]
  s_waitcnt lgkmcnt(13)
  v_lshlrev_b32 v40, 16, v36
  v_and_b32 v41, s59, v36
  v_pk_mul_f32 v[224:225], v[40:41], v[224:225]
  v_lshlrev_b32 v40, 16, v37
  v_and_b32 v41, s59, v37
  v_pk_mul_f32 v[226:227], v[40:41], v[226:227]
  s_waitcnt lgkmcnt(12)
  v_lshlrev_b32 v40, 16, v38
  v_and_b32 v41, s59, v38
  v_pk_mul_f32 v[228:229], v[40:41], v[228:229]
  v_lshlrev_b32 v40, 16, v39
  v_and_b32 v41, s59, v39
  v_pk_mul_f32 v[230:231], v[40:41], v[230:231]
  s_waitcnt lgkmcnt(10)
  v_pk_add_f32 v[80:81], v[80:81], v[96:97]
  v_pk_add_f32 v[82:83], v[82:83], v[98:99]
  s_waitcnt lgkmcnt(9)
  v_pk_add_f32 v[64:65], v[64:65], v[112:113]
  v_pk_add_f32 v[66:67], v[66:67], v[114:115]
  v_pk_add_f32 v[64:65], v[64:65], v[80:81]
  v_pk_add_f32 v[66:67], v[66:67], v[82:83]
  s_waitcnt lgkmcnt(7)
  v_pk_add_f32 v[84:85], v[84:85], v[100:101]
  v_pk_add_f32 v[86:87], v[86:87], v[102:103]
  s_waitcnt lgkmcnt(6)
  v_pk_add_f32 v[68:69], v[68:69], v[116:117]
  v_pk_add_f32 v[70:71], v[70:71], v[118:119]
  v_pk_add_f32 v[68:69], v[68:69], v[84:85]
  v_pk_add_f32 v[70:71], v[70:71], v[86:87]
  v_pk_mul_f32 v[56:57], v[64:65], s[62:63] op_sel_hi:[1,0]
  v_pk_mul_f32 v[58:59], v[66:67], s[62:63] op_sel_hi:[1,0]
  v_pk_mul_f32 v[60:61], v[68:69], s[62:63] op_sel_hi:[1,0]
  v_pk_mul_f32 v[62:63], v[70:71], s[62:63] op_sel_hi:[1,0]
  v_exp_f32 v56, v56
  v_exp_f32 v57, v57
  v_exp_f32 v58, v58
  v_exp_f32 v59, v59
  v_exp_f32 v60, v60
  v_exp_f32 v61, v61
  v_exp_f32 v62, v62
  v_exp_f32 v63, v63
  v_pk_mul_f32 v[64:65], v[64:65], v[216:217]
  v_pk_mul_f32 v[66:67], v[66:67], v[218:219]
  v_pk_mul_f32 v[68:69], v[68:69], v[220:221]
  v_pk_mul_f32 v[70:71], v[70:71], v[222:223]
  v_pk_add_f32 v[56:57], v[56:57], 1.0 op_sel_hi:[1,0]
  v_pk_add_f32 v[58:59], v[58:59], 1.0 op_sel_hi:[1,0]
  v_pk_add_f32 v[60:61], v[60:61], 1.0 op_sel_hi:[1,0]
  v_pk_add_f32 v[62:63], v[62:63], 1.0 op_sel_hi:[1,0]
  v_rcp_f32 v56, v56
  v_rcp_f32 v57, v57
  v_rcp_f32 v58, v58
  v_rcp_f32 v59, v59
  v_rcp_f32 v60, v60
  v_rcp_f32 v61, v61
  v_rcp_f32 v62, v62
  v_rcp_f32 v63, v63
  s_nop 0
  v_pk_fma_f32 v[56:57], v[56:57], v[64:65], v[200:201]
  v_pk_fma_f32 v[58:59], v[58:59], v[66:67], v[202:203]
  v_pk_fma_f32 v[60:61], v[60:61], v[68:69], v[204:205]
  v_pk_fma_f32 v[62:63], v[62:63], v[70:71], v[206:207]
  v_cvt_pk_bf16_f32 v232, v56, v57
  v_cvt_pk_bf16_f32 v233, v58, v59
  v_cvt_pk_bf16_f32 v234, v60, v61
  v_cvt_pk_bf16_f32 v235, v62, v63
  s_nop 1
  v_permlane32_swap_b32 v232, v234
  v_permlane32_swap_b32 v233, v235
  ds_write_b128 v54, v[232:235]
  s_waitcnt lgkmcnt(5)
  v_pk_add_f32 v[88:89], v[88:89], v[104:105]
  v_pk_add_f32 v[90:91], v[90:91], v[106:107]
  s_waitcnt lgkmcnt(4)
  v_pk_add_f32 v[72:73], v[72:73], v[120:121]
  v_pk_add_f32 v[74:75], v[74:75], v[122:123]
  v_pk_add_f32 v[72:73], v[72:73], v[88:89]
  v_pk_add_f32 v[74:75], v[74:75], v[90:91]
  s_waitcnt lgkmcnt(2)
  v_pk_add_f32 v[92:93], v[92:93], v[108:109]
  v_pk_add_f32 v[94:95], v[94:95], v[110:111]
  s_waitcnt lgkmcnt(1)
  v_pk_add_f32 v[76:77], v[76:77], v[124:125]
  v_pk_add_f32 v[78:79], v[78:79], v[126:127]
  v_pk_add_f32 v[76:77], v[76:77], v[92:93]
  v_pk_add_f32 v[78:79], v[78:79], v[94:95]
  v_pk_mul_f32 v[56:57], v[72:73], s[62:63] op_sel_hi:[1,0]
  v_pk_mul_f32 v[58:59], v[74:75], s[62:63] op_sel_hi:[1,0]
  v_pk_mul_f32 v[60:61], v[76:77], s[62:63] op_sel_hi:[1,0]
  v_pk_mul_f32 v[62:63], v[78:79], s[62:63] op_sel_hi:[1,0]
  v_exp_f32 v56, v56
  v_exp_f32 v57, v57
  v_exp_f32 v58, v58
  v_exp_f32 v59, v59
  v_exp_f32 v60, v60
  v_exp_f32 v61, v61
  v_exp_f32 v62, v62
  v_exp_f32 v63, v63
  v_pk_mul_f32 v[72:73], v[72:73], v[224:225]
  v_pk_mul_f32 v[74:75], v[74:75], v[226:227]
  v_pk_mul_f32 v[76:77], v[76:77], v[228:229]
  v_pk_mul_f32 v[78:79], v[78:79], v[230:231]
  v_pk_add_f32 v[56:57], v[56:57], 1.0 op_sel_hi:[1,0]
  v_pk_add_f32 v[58:59], v[58:59], 1.0 op_sel_hi:[1,0]
  v_pk_add_f32 v[60:61], v[60:61], 1.0 op_sel_hi:[1,0]
  v_pk_add_f32 v[62:63], v[62:63], 1.0 op_sel_hi:[1,0]
  v_rcp_f32 v56, v56
  v_rcp_f32 v57, v57
  v_rcp_f32 v58, v58
  v_rcp_f32 v59, v59
  v_rcp_f32 v60, v60
  v_rcp_f32 v61, v61
  v_rcp_f32 v62, v62
  v_rcp_f32 v63, v63
  s_nop 0
  v_pk_fma_f32 v[56:57], v[56:57], v[72:73], v[208:209]
  v_pk_fma_f32 v[58:59], v[58:59], v[74:75], v[210:211]
  v_pk_fma_f32 v[60:61], v[60:61], v[76:77], v[212:213]
  v_pk_fma_f32 v[62:63], v[62:63], v[78:79], v[214:215]
  v_cvt_pk_bf16_f32 v236, v56, v57
  v_cvt_pk_bf16_f32 v237, v58, v59
  v_cvt_pk_bf16_f32 v238, v60, v61
  v_cvt_pk_bf16_f32 v239, v62, v63
  s_nop 1
  v_permlane32_swap_b32 v236, v238
  v_permlane32_swap_b32 v237, v239
  ds_write_b128 v55, v[236:239]
  s_waitcnt lgkmcnt(0)
  s_barrier
  ds_read_b128 v[232:235], v30 offset:0
  ds_read_b128 v[236:239], v30 offset:1024
  s_waitcnt lgkmcnt(1)
  buffer_store_dwordx4 v[232:235], v31, s[36:39], s72 offen sc1
  s_waitcnt lgkmcnt(0)
  buffer_store_dwordx4 v[236:239], v31, s[36:39], s73 offen sc1
  s_or_b32 s62, s2, s56
  s_cmp_lg_u32 s62, 0
  s_cbranch_scc1 L_FIN
  s_mov_b32 s96, 0xa60000
  v_mov_b32 v249, s96
  s_mov_b64 exec, 1
  buffer_store_dword v255, v249, s[32:35], 0 offen sc1
  s_mov_b64 exec, -1
  s_branch L_FIN
L_HELP:
  buffer_load_dword v253, v29, s[48:51], s72 offen
  s_add_u32 s72, s72, 262144
  buffer_load_dword v253, v29, s[48:51], s72 offen
  s_add_u32 s72, s72, 262144
  buffer_load_dword v253, v29, s[48:51], s72 offen
  s_add_u32 s72, s72, 262144
  buffer_load_dword v253, v29, s[48:51], s72 offen
  s_add_u32 s72, s72, 262144
  buffer_load_dword v253, v29, s[48:51], s72 offen
  s_add_u32 s72, s72, 262144
  s_cmp_lt_u32 s75, 4
  s_cselect_b32 s72, s72, s50
  buffer_load_dword v253, v29, s[48:51], s72 offen
  s_add_u32 s72, s72, 262144
L_FIN:
L_END:
  s_endpgm
.section .rodata,"a"
.p2align 6
.amdhsa_kernel recurrent_scan__ssm_conv_h3__mixer_token_mlp__prompt_kernel
  .amdhsa_next_free_vgpr 512
  .amdhsa_next_free_sgpr 102
  .amdhsa_accum_offset 256
  .amdhsa_group_segment_fixed_size 0
  .amdhsa_kernarg_size 112
  .amdhsa_user_sgpr_count 2
  .amdhsa_user_sgpr_kernarg_segment_ptr 1
  .amdhsa_system_sgpr_workgroup_id_x 1
.end_amdhsa_kernel
```
